```python
import torch

def _softmax(x, axis=-1):
    return torch.softmax(x, dim=axis)
def _gelu(x):
    return torch.nn.functional.gelu(x, approximate="tanh")
def _silu(x):
    return torch.nn.functional.silu(x)
def _sigmoid(x):
    return torch.sigmoid(x)
def _layernorm(x, axis=-1, eps=1e-5):
    m = x.mean(dim=axis, keepdim=True)
    v = x.var(dim=axis, keepdim=True, unbiased=False)
    return (x - m) / torch.sqrt(v + eps)
def _scatter_add(tgt, idx, src, axis=0):
    return tgt.clone().index_add_(axis, idx, src)
def _segment_sum(src, seg, n):
    out = torch.zeros((n,) + src.shape[1:], dtype=src.dtype)
    return out.index_add_(0, seg, src)
def _pad(x, pw):
    flat = tuple(v for pair in reversed(pw) for v in pair)
    return torch.nn.functional.pad(x, flat)

kernel_name = 'recurrent_scan__ssm_conv_s4__mixer_s_mlp__prompt'

def setup_inputs():

    _w = (lambda a: (lambda t: t.to(torch.bfloat16) if t.is_floating_point() else t)(torch.as_tensor(a)))
    def _A_setup():
        B, L, D, N = 1, 2048, 448, 256
        A_re = -(lambda _x: torch.exp(torch.as_tensor(_x)))((lambda *s: torch.randn(*s, dtype=torch.bfloat16) * 3.2)(D, N))
        A_im = torch.pi * (lambda *s: torch.randn(*s, dtype=torch.bfloat16) * 0.05)(D, N)
        B_re = (lambda *s: torch.randn(*s, dtype=torch.bfloat16) * 0.1)(D, N)
        B_im = (lambda *s: torch.randn(*s, dtype=torch.bfloat16) * 0.1)(D, N)
        C_re = (lambda *s: torch.randn(*s, dtype=torch.bfloat16) * 0.1)(D, N)
        C_im = (lambda *s: torch.randn(*s, dtype=torch.bfloat16) * 0.1)(D, N)
        log_dt = (lambda *s: torch.randn(*s, dtype=torch.bfloat16) * 0.05)(D) * 0.5 - 4.0
        Dskip = (lambda *s: torch.randn(*s, dtype=torch.bfloat16) * 0.05)(D)
        return {
            "u": _w((lambda *s: torch.randn(*s, dtype=torch.bfloat16) * 0.05)(B, L, D)),
            "A_re": _w(A_re),
            "A_im": _w(A_im),
            "B_re": _w(B_re),
            "B_im": _w(B_im),
            "C_re": _w(C_re),
            "C_im": _w(C_im),
            "log_dt": _w(log_dt),
            "Dskip": _w(Dskip),
        }
    _A_in = _A_setup()

    def _B_setup():
        B, S, D, F = 1, 2048, 448, 1792
        return {
            "x":  _w((lambda *s: torch.randn(*s, dtype=torch.bfloat16) * 0.05)(B, S, D)),
            "w1": _w((lambda *s: torch.randn(*s, dtype=torch.bfloat16) * 3.2)(D, D) * (D ** -0.5)),
            "w2": _w((lambda *s: torch.randn(*s, dtype=torch.bfloat16) * 3.2)(D, D) * (D ** -0.5)),
            "w3": _w((lambda *s: torch.randn(*s, dtype=torch.bfloat16) * 3.2)(D, F) * (D ** -0.5)),
            "w4": _w((lambda *s: torch.randn(*s, dtype=torch.bfloat16) * 3.2)(F, D) * (F ** -0.5)),
        }
    _B_in = _B_setup()

    return {
        "A_u": _A_in["u"],
        "A_A_re": _A_in["A_re"],
        "A_A_im": _A_in["A_im"],
        "A_B_re": _A_in["B_re"],
        "A_B_im": _A_in["B_im"],
        "A_C_re": _A_in["C_re"],
        "A_C_im": _A_in["C_im"],
        "A_log_dt": _A_in["log_dt"],
        "A_Dskip": _A_in["Dskip"],
        "B_x": _B_in["x"],
        "B_w1": _B_in["w1"],
        "B_w2": _B_in["w2"],
        "B_w3": _B_in["w3"],
        "B_w4": _B_in["w4"],
    }

def reference(A_u, A_A_re, A_A_im, A_B_re, A_B_im, A_C_re, A_C_im, A_log_dt, A_Dskip, B_x, B_w1, B_w2, B_w3, B_w4):
    def _A_ref(u, A_re, A_im, B_re, B_im, C_re, C_im, log_dt, Dskip):
        Bsz, L, D = u.shape
        dt = torch.exp(log_dt)[:, None]
        A = A_re + 1j * A_im
        Bc = B_re + 1j * B_im
        Cc = C_re + 1j * C_im
        logdA = dt * A
        dB = dt * Bc
        l = (lambda x, dt: x.to(dt))(torch.arange(L), A_re.dtype)
        P = torch.exp(logdA[:, :, None] * l[None, None, :])
        K = torch.einsum("dn,dnl,dn->dl", Cc, P, dB).real
        L2 = 2 * L
        Kp = _pad(K, ((0, 0), (0, L)))
        up = (lambda x, *d: x.permute(*d))(u, 0, 2, 1)
        up = _pad(up, ((0, 0), (0, 0), (0, L)))
        Kf = (lambda x, axes=(-2,-1): torch.fft.rfft2(x.float(), dim=axes))(Kp[:, None, :], axes=(-2, -1))
        Uf = (lambda x, axes=(-2,-1): torch.fft.rfft2(x.float(), dim=axes))(up[:, :, None, :], axes=(-2, -1))
        Yf = Uf * Kf[None, :, :, :]
        y = (lambda x, s, axes=(-2,-1): torch.fft.irfft2(x, s=s, dim=axes).to(torch.bfloat16))(Yf, (1, L2), axes=(-2, -1))[:, :, 0, :L]
        y = (lambda x, *d: x.permute(*d))(y, 0, 2, 1) + u * Dskip[None, None, :]
        return y

    def _B_ref(x, w1, w2, w3, w4):
        B, S, D = x.shape
        h = _gelu(_layernorm(x, axis=-1) @ w1)
        c = D // 4
        g0 = _pad(h[:, :, 0*c:1*c], ((0, 0), (1, 0), (0, 0)))[:, :S, :]
        g1 = _pad(h[:, :, 1*c:2*c], ((0, 0), (0, 1), (0, 0)))[:, 1:, :]
        g2 = _pad(h[:, :, 2*c:3*c], ((0, 0), (2, 0), (0, 0)))[:, :S, :]
        g3 = _pad(h[:, :, 3*c:   ], ((0, 0), (0, 2), (0, 0)))[:, 2:, :]
        hs = torch.concatenate([g0, g1, g2, g3], axis=-1) @ w2
        x1 = x + hs
        h2 = _gelu(_layernorm(x1, axis=-1) @ w3) @ w4
        return x1 + h2

    x = A_u
    xn = _layernorm(x, axis=-1)
    s = _A_ref(xn, A_A_re, A_A_im, A_B_re, A_B_im, A_C_re, A_C_im, A_log_dt, A_Dskip)
    g = _silu(_B_ref(xn, B_w1, B_w2, B_w3, B_w4))
    return x + s * g
```

```asm
; @launch grid=(256,1,1) block=(512,1,1) lds=163840
.amdgcn_target "amdgcn-amd-amdhsa--gfx950"
.text
.globl recurrent_scan__ssm_conv_s4__mixer_s_mlp__prompt_kernel
.p2align 8
.type recurrent_scan__ssm_conv_s4__mixer_s_mlp__prompt_kernel,@function
recurrent_scan__ssm_conv_s4__mixer_s_mlp__prompt_kernel:
    s_load_dwordx16 s[16:31], s[0:1], 0
    s_load_dwordx16 s[32:47], s[0:1], 64
    s_load_dwordx2 s[48:49], s[0:1], 128
    s_cmp_ge_u32 s2, 256
    s_cbranch_scc1 L_exit
    s_getpc_b64 s[96:97]
L_pc:
    s_sub_u32 s96, s96, L_pc-recurrent_scan__ssm_conv_s4__mixer_s_mlp__prompt_kernel
    s_subb_u32 s97, s97, 0
    s_lshr_b32 s3, s2, 3
    v_lshrrev_b32 v2, 6, v0
    v_and_b32 v1, 63, v0
    s_lshl_b32 s70, s3, 3
    v_lshl_add_u32 v3, v1, 7, v2
    v_add_u32 v3, s70, v3
    v_and_b32 v3, 255, v3
    v_and_b32 v4, 2, v1
    v_lshl_add_u32 v3, v4, 7, v3
    v_min_u32 v3, (L_code_end-recurrent_scan__ssm_conv_s4__mixer_s_mlp__prompt_kernel)/128, v3
    v_lshlrev_b32 v3, 7, v3
    v_readfirstlane_b32 s51, v2
    v_mov_b32 v140, v3
    s_mov_b64 exec, 15
    global_load_dword v2, v140, s[96:97]
    s_mov_b64 exec, -1
    s_mov_b32 s64, s2
    s_mul_i32 s70, s3, 37
    s_lshr_b32 s70, s70, 8
    s_mul_i32 s71, s70, 7
    s_sub_u32 s65, s3, s71
    s_and_b32 s71, s2, 7
    s_lshl_b32 s71, s71, 2
    s_add_u32 s66, s71, s70
    s_lshl_b32 s67, s66, 6
    v_mov_b32 v3, 0
    v_lshlrev_b32 v9, 4, v1
    s_lshl_b32 s99, s70, 1
    s_cmp_ge_u32 s2, 224
    s_cbranch_scc1 L_helper
    v_lshrrev_b32 v5, 3, v1
    v_and_b32 v6, 7, v1
    v_lshlrev_b32 v7, 1, v5
    v_and_b32 v7, 4, v7
    v_xor_b32 v7, v6, v7
    v_mul_u32_u24 v5, 896, v5
    v_lshl_add_u32 v8, v7, 4, v5
    s_and_b32 s100, s51, 1
    s_lshl_b32 s100, s100, 2
    v_lshrrev_b32 v7, 4, v1
    v_or_b32 v7, s100, v7
    v_xor_b32 v6, v6, v7
    v_lshl_add_u32 v17, v6, 4, v5
    s_mul_i32 s98, s51, 7168
    s_mul_i32 s101, s67, 896
    s_add_u32 s101, s101, s98
    s_lshl_b32 s2, s65, 7
    s_add_u32 s100, s98, s2
    s_lshl_b32 s92, s51, 10
    s_add_u32 s92, s92, 57344
    s_and_b32 s70, s51, 1
    s_lshl_b32 s71, s64, 1
    s_add_u32 s70, s70, s71
    s_lshl_b32 s70, s70, 9
    s_lshr_b32 s71, s51, 1
    s_lshl_b32 s71, s71, 7
    s_add_u32 s70, s70, s71
    v_and_b32 v6, 7, v1
    v_lshl_add_u32 v135, v6, 4, s70
    s_waitcnt lgkmcnt(0)
    s_mov_b32 s52, s16
    s_and_b32 s53, s17, 0xffff
    s_mov_b32 s54, 1835008
    s_mov_b32 s55, 0x20000
    s_mov_b32 s12, s36
    s_and_b32 s13, s37, 0xffff
    s_mov_b32 s14, 401408
    s_mov_b32 s15, 0x20000
    s_mov_b32 s70, s65
    s_lshl_b32 s71, s70, 10
    s_add_u32 m0, s98, s71
    s_lshl_b32 s70, s70, 7
    s_add_u32 s70, s70, s101
    buffer_load_dwordx4 v17, s[52:55], s70 offen lds
    s_mov_b32 s70, s99
    s_lshl_b32 s71, s70, 13
    s_add_u32 m0, s92, s71
    s_mul_i32 s70, s70, 57344
    s_add_u32 s70, s70, s100
    buffer_load_dwordx4 v8, s[12:15], s70 offen lds
    s_add_u32 s70, s99, 1
    s_sub_u32 s71, s70, 7
    s_min_u32 s70, s70, s71
    s_lshl_b32 s71, s70, 13
    s_add_u32 m0, s92, s71
    s_mul_i32 s70, s70, 57344
    s_add_u32 s70, s70, s100
    buffer_load_dwordx4 v8, s[12:15], s70 offen lds
    s_add_u32 s70, s65, 1
    s_sub_u32 s71, s70, 7
    s_min_u32 s70, s70, s71
    s_lshl_b32 s71, s70, 10
    s_add_u32 m0, s98, s71
    s_lshl_b32 s70, s70, 7
    s_add_u32 s70, s70, s101
    buffer_load_dwordx4 v17, s[52:55], s70 offen lds
    s_add_u32 s70, s65, 2
    s_sub_u32 s71, s70, 7
    s_min_u32 s70, s70, s71
    s_lshl_b32 s71, s70, 10
    s_add_u32 m0, s98, s71
    s_lshl_b32 s70, s70, 7
    s_add_u32 s70, s70, s101
    buffer_load_dwordx4 v17, s[52:55], s70 offen lds
    s_lshl_b32 s70, s64, 2
    s_load_dword s34, s[30:31], s70
    s_load_dword s35, s[32:33], s70
    s_mov_b32 s4, s48
    s_and_b32 s5, s49, 0xffff
    s_mov_b32 s6, 268435456
    s_mov_b32 s7, 0x20000
    s_mov_b32 s8, s44
    s_and_b32 s9, s45, 0xffff
    s_mov_b32 s10, 1835008
    s_mov_b32 s11, 0x20000
    s_mov_b32 s56, s40
    s_and_b32 s57, s41, 0xffff
    s_mov_b32 s58, 1605632
    s_mov_b32 s59, 0x20000
    s_mov_b32 s60, s42
    s_and_b32 s61, s43, 0xffff
    s_mov_b32 s62, 1605632
    s_mov_b32 s63, 0x20000
    s_cmp_lt_u32 s51, 4
    s_cbranch_scc1 L_main1
    s_sub_u32 s94, s51, 4
    s_mov_b32 s40, s99
    s_lshl_b32 s40, s40, 10
    s_add_u32 s41, s99, 1
    s_sub_u32 s71, s41, 7
    s_min_u32 s41, s41, s71
    s_lshl_b32 s41, s41, 10
    s_add_u32 s42, s99, 2
    s_sub_u32 s71, s42, 7
    s_min_u32 s42, s42, s71
    s_lshl_b32 s42, s42, 10
    s_add_u32 s43, s99, 3
    s_sub_u32 s71, s43, 7
    s_min_u32 s43, s43, s71
    s_lshl_b32 s43, s43, 10
    s_add_u32 s44, s99, 4
    s_sub_u32 s71, s44, 7
    s_min_u32 s44, s44, s71
    s_lshl_b32 s44, s44, 10
    s_add_u32 s45, s99, 5
    s_sub_u32 s71, s45, 7
    s_min_u32 s45, s45, s71
    s_lshl_b32 s45, s45, 10
    s_add_u32 s46, s99, 6
    s_sub_u32 s71, s46, 7
    s_min_u32 s46, s46, s71
    s_lshl_b32 s46, s46, 10
    v_lshlrev_b32 v5, 2, v1
    v_add_u32 v5, 163328, v5
    ds_write_b32 v5, v3
    s_and_b32 s70, s94, 1
    s_lshl_b32 s70, s70, 10
    v_add_u32 v21, s70, v9
    s_add_u32 s96, s96, L_tbl-recurrent_scan__ssm_conv_s4__mixer_s_mlp__prompt_kernel
    s_addc_u32 s97, s97, 0
    v_and_b32 v7, 15, v1
    s_lshl_b32 s70, s94, 4
    v_add_u32 v7, s70, v7
    v_bfe_u32 v5, v7, 1, 3
    v_lshrrev_b32 v6, 3, v7
    v_mul_u32_u24 v6, 7168, v6
    v_and_b32 v7, 7, v7
    v_lshl_add_u32 v7, v7, 7, v6
    v_lshrrev_b32 v6, 4, v1
    v_add_u32 v18, 0, v6
    v_xor_b32 v18, v18, v5
    v_lshl_add_u32 v18, v18, 4, v7
    v_add_u32 v19, 4, v6
    v_xor_b32 v19, v19, v5
    v_lshl_add_u32 v19, v19, 4, v7
    s_and_b32 s95, s94, 1
    v_bfe_u32 v5, v1, 2, 2
    v_lshrrev_b32 v6, 5, v1
    v_lshl_add_u32 v6, v6, 3, v5
    v_lshlrev_b32 v20, 7, v6
    v_lshrrev_b32 v5, 1, v5
    v_xor_b32 v5, s95, v5
    v_lshl_add_u32 v20, v5, 6, v20
    v_bfe_u32 v5, v1, 4, 1
    v_lshl_add_u32 v20, v5, 5, v20
    v_and_b32 v5, 3, v1
    v_lshl_add_u32 v20, v5, 3, v20
    v_add_u32 v20, 57344, v20
    s_lshr_b32 s70, s94, 1
    s_lshl_b32 s70, s70, 11
    v_add_u32 v20, s70, v20
    v_lshrrev_b32 v6, 4, v1
    v_mov_b32 v28, 0x3f803f80
    v_mov_b32 v24, 0
    v_mov_b32 v29, 0x3f803f80
    v_mov_b32 v25, 0
    v_mov_b32 v30, 0x3f803f80
    v_mov_b32 v26, 0
    v_mov_b32 v31, 0x3f803f80
    v_mov_b32 v27, 0
    s_mov_b32 exec_lo, 0x00020001
    s_mov_b32 exec_hi, 0x00020001
    v_mov_b32 v24, 0x3f803f80
    v_mov_b32 v25, 0x3f803f80
    v_mov_b32 v26, 0x3f803f80
    v_mov_b32 v27, 0x3f803f80
    s_mov_b64 exec, -1
    s_mov_b32 exec_hi, 0
    s_mov_b32 exec_lo, 255
    v_mov_b32 v12, s18
    v_mov_b32 v13, s19
    s_mov_b32 exec_lo, 65280
    v_mov_b32 v12, s20
    v_mov_b32 v13, s21
    s_mov_b32 exec_lo, 16711680
    v_mov_b32 v12, s22
    v_mov_b32 v13, s23
    s_mov_b32 exec_lo, 4278190080
    v_mov_b32 v12, s24
    v_mov_b32 v13, s25
    s_mov_b32 exec_lo, 0
    s_mov_b32 exec_hi, 0xFF
    v_mov_b32 v12, s26
    v_mov_b32 v13, s27
    s_mov_b32 exec_hi, 0xFF00
    v_mov_b32 v12, s28
    v_mov_b32 v13, s29
    s_mov_b32 exec_lo, -1
    s_mov_b32 exec_hi, 0xFFFF
    v_add_co_u32 v12, vcc, v12, v135
    s_nop 1
    v_addc_co_u32 v13, vcc, 0, v13, vcc
    s_mov_b64 exec, -1
    s_lshl_b32 s18, s51, 10
    s_add_u32 s18, s18, 150528
    s_add_u32 s70, s65, 3
    s_sub_u32 s71, s70, 7
    s_min_u32 s70, s70, s71
    s_lshl_b32 s71, s70, 10
    s_add_u32 m0, s98, s71
    s_lshl_b32 s70, s70, 7
    s_add_u32 s70, s70, s101
    buffer_load_dwordx4 v17, s[52:55], s70 offen lds
    s_add_u32 s70, s65, 4
    s_sub_u32 s71, s70, 7
    s_min_u32 s70, s70, s71
    s_lshl_b32 s71, s70, 10
    s_add_u32 m0, s98, s71
    s_lshl_b32 s70, s70, 7
    s_add_u32 s70, s70, s101
    buffer_load_dwordx4 v17, s[52:55], s70 offen lds
    s_add_u32 s70, s65, 5
    s_sub_u32 s71, s70, 7
    s_min_u32 s70, s70, s71
    s_lshl_b32 s71, s70, 10
    s_add_u32 m0, s98, s71
    s_lshl_b32 s70, s70, 7
    s_add_u32 s70, s70, s101
    buffer_load_dwordx4 v17, s[52:55], s70 offen lds
    s_add_u32 s70, s65, 6
    s_sub_u32 s71, s70, 7
    s_min_u32 s70, s70, s71
    s_lshl_b32 s71, s70, 10
    s_add_u32 m0, s98, s71
    s_lshl_b32 s70, s70, 7
    s_add_u32 s70, s70, s101
    buffer_load_dwordx4 v17, s[52:55], s70 offen lds
    s_lshl_b32 s71, s42, 3
    s_add_u32 m0, s92, s71
    s_mul_i32 s70, s42, 56
    s_add_u32 s70, s70, s100
    buffer_load_dwordx4 v8, s[12:15], s70 offen lds
    s_lshl_b32 s71, s43, 3
    s_add_u32 m0, s92, s71
    s_mul_i32 s70, s43, 56
    s_add_u32 s70, s70, s100
    buffer_load_dwordx4 v8, s[12:15], s70 offen lds
    s_lshl_b32 s71, s44, 3
    s_add_u32 m0, s92, s71
    s_mul_i32 s70, s44, 56
    s_add_u32 s70, s70, s100
    buffer_load_dwordx4 v8, s[12:15], s70 offen lds
    s_lshl_b32 s71, s45, 3
    s_add_u32 m0, s92, s71
    s_mul_i32 s70, s45, 56
    s_add_u32 s70, s70, s100
    buffer_load_dwordx4 v8, s[12:15], s70 offen lds
    s_lshl_b32 s71, s46, 3
    s_add_u32 m0, s92, s71
    s_mul_i32 s70, s46, 56
    s_add_u32 s70, s70, s100
    buffer_load_dwordx4 v8, s[12:15], s70 offen lds
    s_lshl_b32 s99, s51, 12
    s_add_u32 s99, s99, 24576
    s_lshl_b32 s98, s51, 12
    s_add_u32 s98, s98, 114688
    s_mov_b32 s49, s2
    buffer_load_dword v4, v3, s[4:7], 0 offen sc1
    s_branch L_side1
L_main1:
    s_and_b32 s94, s51, 1
    s_lshr_b32 s95, s51, 1
    v_and_b32 v10, 31, v1
    s_lshl_b32 s70, s95, 5
    v_add_u32 v10, s70, v10
    v_bfe_u32 v5, v10, 1, 3
    v_lshrrev_b32 v6, 3, v10
    v_mul_u32_u24 v7, 7168, v6
    v_and_b32 v6, 7, v10
    v_lshl_add_u32 v7, v6, 7, v7
    v_lshrrev_b32 v6, 5, v1
    v_add_u32 v18, 0, v6
    v_xor_b32 v18, v18, v5
    v_lshl_add_u32 v18, v18, 4, v7
    v_add_u32 v19, 2, v6
    v_xor_b32 v19, v19, v5
    v_lshl_add_u32 v19, v19, 4, v7
    v_add_u32 v20, 4, v6
    v_xor_b32 v20, v20, v5
    v_lshl_add_u32 v20, v20, 4, v7
    v_add_u32 v21, 6, v6
    v_xor_b32 v21, v21, v5
    v_lshl_add_u32 v21, v21, 4, v7
    s_lshl_b32 s70, s94, 2
    v_lshl_add_u32 v7, v6, 3, v7
    s_lshl_b32 s71, s65, 10
    v_add_u32 v7, s71, v7
    s_add_u32 s71, s70, 0
    v_xor_b32 v23, s71, v5
    v_lshl_add_u32 v23, v23, 4, v7
    s_add_u32 s71, s70, 1
    v_xor_b32 v24, s71, v5
    v_lshl_add_u32 v24, v24, 4, v7
    s_add_u32 s71, s70, 2
    v_xor_b32 v25, s71, v5
    v_lshl_add_u32 v25, v25, 4, v7
    s_add_u32 s71, s70, 3
    v_xor_b32 v26, s71, v5
    v_lshl_add_u32 v26, v26, 4, v7
    v_lshrrev_b32 v6, 4, v1
    s_lshl_b32 s70, s51, 1
    s_lshl_b32 s71, s65, 10
    v_bfe_u32 v5, v1, 2, 2
    v_add_u32 v5, 0, v5
    v_lshl_add_u32 v7, v6, 3, v5
    v_bfe_u32 v7, v7, 1, 3
    v_lshlrev_b32 v5, 7, v5
    v_bfe_u32 v27, v1, 1, 1
    v_add_u32 v27, s70, v27
    v_xor_b32 v27, v27, v7
    v_lshl_add_u32 v5, v27, 4, v5
    v_and_b32 v7, 1, v1
    v_lshl_add_u32 v5, v7, 3, v5
    v_mul_u32_u24 v7, 7168, v6
    v_add3_u32 v27, s71, v5, v7
    v_bfe_u32 v5, v1, 2, 2
    v_add_u32 v5, 4, v5
    v_lshl_add_u32 v7, v6, 3, v5
    v_bfe_u32 v7, v7, 1, 3
    v_lshlrev_b32 v5, 7, v5
    v_bfe_u32 v28, v1, 1, 1
    v_add_u32 v28, s70, v28
    v_xor_b32 v28, v28, v7
    v_lshl_add_u32 v5, v28, 4, v5
    v_and_b32 v7, 1, v1
    v_lshl_add_u32 v5, v7, 3, v5
    v_mul_u32_u24 v7, 7168, v6
    v_add3_u32 v28, s71, v5, v7
    v_bfe_u32 v5, v1, 2, 2
    v_lshrrev_b32 v6, 5, v1
    v_lshl_add_u32 v6, v6, 3, v5
    v_lshlrev_b32 v22, 7, v6
    v_lshrrev_b32 v5, 1, v5
    v_xor_b32 v5, s94, v5
    v_lshl_add_u32 v22, v5, 6, v22
    v_bfe_u32 v5, v1, 4, 1
    v_lshl_add_u32 v22, v5, 5, v22
    v_and_b32 v5, 3, v1
    v_lshl_add_u32 v22, v5, 3, v22
    v_add_u32 v22, 57344, v22
    s_mov_b32 s40, s99
    s_lshl_b32 s40, s40, 10
    s_add_u32 s41, s99, 1
    s_sub_u32 s71, s41, 7
    s_min_u32 s41, s41, s71
    s_lshl_b32 s41, s41, 10
    s_add_u32 s42, s99, 2
    s_sub_u32 s71, s42, 7
    s_min_u32 s42, s42, s71
    s_lshl_b32 s42, s42, 10
    s_add_u32 s43, s99, 3
    s_sub_u32 s71, s43, 7
    s_min_u32 s43, s43, s71
    s_lshl_b32 s43, s43, 10
    s_add_u32 s44, s99, 4
    s_sub_u32 s71, s44, 7
    s_min_u32 s44, s44, s71
    s_lshl_b32 s44, s44, 10
    s_add_u32 s45, s99, 5
    s_sub_u32 s71, s45, 7
    s_min_u32 s45, s45, s71
    s_lshl_b32 s45, s45, 10
    s_add_u32 s46, s99, 6
    s_sub_u32 s71, s46, 7
    s_min_u32 s46, s46, s71
    s_lshl_b32 s46, s46, 10
    s_mov_b32 exec_hi, 0
    s_mov_b32 exec_lo, 255
    v_mov_b32 v12, s18
    v_mov_b32 v13, s19
    s_mov_b32 exec_lo, 65280
    v_mov_b32 v12, s20
    v_mov_b32 v13, s21
    s_mov_b32 exec_lo, 16711680
    v_mov_b32 v12, s22
    v_mov_b32 v13, s23
    s_mov_b32 exec_lo, 4278190080
    v_mov_b32 v12, s24
    v_mov_b32 v13, s25
    s_mov_b32 exec_lo, 0
    s_mov_b32 exec_hi, 0xFF
    v_mov_b32 v12, s26
    v_mov_b32 v13, s27
    s_mov_b32 exec_hi, 0xFF00
    v_mov_b32 v12, s28
    v_mov_b32 v13, s29
    s_mov_b32 exec_lo, -1
    s_mov_b32 exec_hi, 0xFFFF
    v_add_co_u32 v12, vcc, v12, v135
    s_nop 1
    v_addc_co_u32 v13, vcc, 0, v13, vcc
    s_mov_b64 exec, -1
    s_lshl_b32 s18, s51, 10
    s_add_u32 s18, s18, 150528
    s_add_u32 s70, s65, 3
    s_sub_u32 s71, s70, 7
    s_min_u32 s70, s70, s71
    s_lshl_b32 s71, s70, 10
    s_add_u32 m0, s98, s71
    s_lshl_b32 s70, s70, 7
    s_add_u32 s70, s70, s101
    buffer_load_dwordx4 v17, s[52:55], s70 offen lds
    s_add_u32 s70, s65, 4
    s_sub_u32 s71, s70, 7
    s_min_u32 s70, s70, s71
    s_lshl_b32 s71, s70, 10
    s_add_u32 m0, s98, s71
    s_lshl_b32 s70, s70, 7
    s_add_u32 s70, s70, s101
    buffer_load_dwordx4 v17, s[52:55], s70 offen lds
    s_add_u32 s70, s65, 5
    s_sub_u32 s71, s70, 7
    s_min_u32 s70, s70, s71
    s_lshl_b32 s71, s70, 10
    s_add_u32 m0, s98, s71
    s_lshl_b32 s70, s70, 7
    s_add_u32 s70, s70, s101
    buffer_load_dwordx4 v17, s[52:55], s70 offen lds
    s_add_u32 s70, s65, 6
    s_sub_u32 s71, s70, 7
    s_min_u32 s70, s70, s71
    s_lshl_b32 s71, s70, 10
    s_add_u32 m0, s98, s71
    s_lshl_b32 s70, s70, 7
    s_add_u32 s70, s70, s101
    buffer_load_dwordx4 v17, s[52:55], s70 offen lds
    s_lshl_b32 s71, s42, 3
    s_add_u32 m0, s92, s71
    s_mul_i32 s70, s42, 56
    s_add_u32 s70, s70, s100
    buffer_load_dwordx4 v8, s[12:15], s70 offen lds
    s_lshl_b32 s71, s43, 3
    s_add_u32 m0, s92, s71
    s_mul_i32 s70, s43, 56
    s_add_u32 s70, s70, s100
    buffer_load_dwordx4 v8, s[12:15], s70 offen lds
    s_lshl_b32 s71, s44, 3
    s_add_u32 m0, s92, s71
    s_mul_i32 s70, s44, 56
    s_add_u32 s70, s70, s100
    buffer_load_dwordx4 v8, s[12:15], s70 offen lds
    s_lshl_b32 s71, s45, 3
    s_add_u32 m0, s92, s71
    s_mul_i32 s70, s45, 56
    s_add_u32 s70, s70, s100
    buffer_load_dwordx4 v8, s[12:15], s70 offen lds
    s_lshl_b32 s71, s46, 3
    s_add_u32 m0, s92, s71
    s_mul_i32 s70, s46, 56
    s_add_u32 s70, s70, s100
    buffer_load_dwordx4 v8, s[12:15], s70 offen lds
    s_mul_i32 s99, s51, 10240
    s_lshl_b32 s98, s51, 12
    s_add_u32 s98, s98, 114688
    s_mov_b32 s49, s2
    s_lshl_b32 s101, s65, 9
    s_lshl_b32 s70, s51, 6
    s_add_u32 s101, s101, s70
    v_lshrrev_b32 v142, 2, v1
    v_mul_u32_u24 v142, 3584, v142
    v_and_b32 v5, 3, v1
    v_lshl_add_u32 v142, v5, 4, v142
    v_lshlrev_b32 v134, 3, v5
    v_bfe_u32 v5, v1, 4, 1
    v_lshl_add_u32 v134, v5, 5, v134
    v_bfe_u32 v5, v1, 2, 2
    v_lshl_add_u32 v134, v5, 6, v134
    v_lshrrev_b32 v5, 5, v1
    v_lshl_add_u32 v134, v5, 8, v134
    v_add_u32 v134, s99, v134
    v_bfe_u32 v5, v1, 2, 2
    v_lshrrev_b32 v6, 5, v1
    v_lshl_add_u32 v6, v6, 2, v5
    v_lshlrev_b32 v29, 7, v6
    v_lshrrev_b32 v5, 1, v5
    v_xor_b32 v5, s94, v5
    v_lshl_add_u32 v29, v5, 6, v29
    v_bfe_u32 v5, v1, 4, 1
    v_lshl_add_u32 v29, v5, 5, v29
    v_and_b32 v5, 3, v1
    v_lshl_add_u32 v29, v5, 3, v29
    v_add_u32 v29, 57344, v29
    s_mul_i32 s70, s94, 28672
    v_add_u32 v29, s70, v29
    v_xor_b32 v30, 64, v29
    v_add_u32 v42, s99, v9
    s_xor_b32 s70, s51, 1
    s_mul_i32 s70, s70, 10240
    v_add_u32 v43, s70, v9
    s_lshl_b32 s29, s66, 1
    s_add_u32 s29, s29, s95
    v_add_u32 v7, s67, v10
    v_lshrrev_b32 v6, 5, v1
    v_lshlrev_b32 v6, 9, v6
    s_xor_b32 s70, s94, 0
    s_add_u32 s71, s70, 1
    v_subrev_u32 v5, s71, v7
    s_mul_i32 s70, s70, 14336
    s_add_u32 s70, s70, 0
    v_lshrrev_b32 v40, 5, v5
    v_mul_u32_u24 v40, 28672, v40
    v_cmp_gt_u32 vcc, 2048, v5
    v_and_b32 v5, 31, v5
    v_lshl_add_u32 v5, v5, 4, v6
    v_add3_u32 v5, v5, v40, s70
    v_mov_b32 v40, 1073741824
    v_cndmask_b32 v40, v40, v5, vcc
    s_xor_b32 s70, s94, 0
    s_add_u32 s71, s70, 1
    v_add_u32 v5, s71, v7
    s_mul_i32 s70, s70, 14336
    s_add_u32 s70, s70, 7168
    v_lshrrev_b32 v41, 5, v5
    v_mul_u32_u24 v41, 28672, v41
    v_cmp_gt_u32 vcc, 2048, v5
    v_and_b32 v5, 31, v5
    v_lshl_add_u32 v5, v5, 4, v6
    v_add3_u32 v5, v5, v41, s70
    v_mov_b32 v41, 1073741824
    v_cndmask_b32 v41, v41, v5, vcc
    s_mul_i32 s26, s29, 1792
    s_add_u32 s26, s26, 17824000
    s_cmp_eq_u32 s29, 0
    s_cselect_b32 s27, 0xFFFFC000, -1
    s_movk_i32 s28, 0x3FF
    s_cmp_eq_u32 s29, 63
    s_cselect_b32 s27, 0x0FFFFFFF, s27
    s_cselect_b32 s28, 0, s28
    s_mov_b32 s24, 1048576
    s_mov_b32 s25, 1052672
    v_lshlrev_b32 v5, 7, v1
    s_lshl_b32 s70, s65, 12
    s_add_u32 s70, s70, 16904192
    v_add_u32 v6, s70, v5
    v_add_u32 v5, s26, v5
    v_cmp_gt_u32 vcc, 48, v1
    s_nop 1
    v_cndmask_b32 v31, v6, v5, vcc
    s_mul_i32 s70, s3, 224
    s_mul_i32 s71, s51, 56
    s_add_u32 s70, s70, s71
    v_add_u32 v5, s70, v1
    v_mul_u32_u24 v6, 9363, v5
    v_lshrrev_b32 v6, 20, v6
    v_mul_u32_u24 v6, 112, v6
    v_add_lshl_u32 v44, v5, v6, 7
    v_lshrrev_b32 v6, 4, v1
    v_lshlrev_b32 v5, 5, v6
    v_add_u32 v47, 161792, v5
    v_and_b32 v7, 15, v1
    v_mul_u32_u24 v45, 144, v7
    v_lshl_add_u32 v45, v6, 4, v45
    v_add_u32 v45, s99, v45
    v_lshrrev_b32 v6, 3, v1
    v_and_b32 v7, 7, v1
    v_mul_u32_u24 v46, 144, v6
    v_lshl_add_u32 v46, v7, 4, v46
    v_add_u32 v46, s99, v46
    v_lshlrev_b32 v6, 12, v6
    v_lshl_add_u32 v48, v7, 4, v6
    s_lshl_b32 s70, s65, 2
    s_add_u32 s70, s70, s51
    s_lshl_b32 s30, s70, 16
    s_lshl_b32 s31, s67, 1
    s_add_u32 s30, s30, s31
    s_add_u32 s30, s30, 12582912
    s_lshl_b32 s70, s70, 12
    s_lshl_b32 s31, s66, 7
    s_add_u32 s31, s31, s70
    s_add_u32 s31, s31, 17039360
    v_lshlrev_b32 v5, 2, v10
    v_add_u32 v60, 161792, v5
    v_and_b32 v6, 31, v1
    s_lshl_b32 s70, s94, 7
    s_add_u32 s70, s70, 162816
    v_lshl_add_u32 v61, v6, 2, s70
    s_lshl_b32 s70, s66, 1
    s_add_u32 s70, s70, s95
    s_mul_i32 s71, s70, 28
    s_lshl_b32 s92, s65, 1
    s_add_u32 s92, s92, s94
    s_lshl_b32 s93, s92, 1
    s_add_u32 s71, s71, s93
    s_lshl_b32 s93, s71, 10
    s_mul_i32 s70, s70, 14
    s_add_u32 s92, s92, s70
    s_lshl_b32 s92, s92, 7
    s_add_u32 s92, s92, 17825792
    s_mul_i32 s32, s66, 7
    s_add_u32 s32, s32, s65
    s_lshl_b32 s32, s32, 2
    s_add_u32 s32, s32, s51
    s_lshl_b32 s32, s32, 7
    s_add_u32 s32, s32, 17956864
    s_add_u32 s100, s93, 1048576
    v_mov_b32 v62, 163408
    s_waitcnt vmcnt(5)
    s_waitcnt lgkmcnt(0)
    s_barrier
    s_mov_b32 m0, s18
    s_mov_b32 exec_hi, 0xFFFF
    global_load_lds_dwordx4 v[12:13], off
    s_mov_b32 exec_hi, -1
    v_lshl_add_u32 v63, s40, 3, v22
    v_add_u32 v49, s40, v18
    ds_read_b64_tr_b16 v[88:89], v63 offset:0
    ds_read_b64_tr_b16 v[90:91], v63 offset:512
    ds_read_b128 v[108:111], v49
    v_add_u32 v49, s40, v19
    ds_read_b64_tr_b16 v[92:93], v63 offset:2048
    ds_read_b64_tr_b16 v[94:95], v63 offset:2560
    ds_read_b128 v[112:115], v49
    v_add_u32 v49, s40, v20
    ds_read_b64_tr_b16 v[96:97], v63 offset:4096
    ds_read_b64_tr_b16 v[98:99], v63 offset:4608
    ds_read_b128 v[116:119], v49
    v_add_u32 v49, s40, v21
    ds_read_b64_tr_b16 v[100:101], v63 offset:6144
    ds_read_b64_tr_b16 v[102:103], v63 offset:6656
    ds_read_b128 v[120:123], v49
    s_waitcnt lgkmcnt(9)
    v_mfma_f32_32x32x16_bf16 v[64:79], v[88:91], v[108:111], 0
    v_lshl_add_u32 v63, s41, 3, v22
    v_add_u32 v49, s41, v18
    ds_read_b64_tr_b16 v[104:105], v63 offset:0
    ds_read_b64_tr_b16 v[106:107], v63 offset:512
    ds_read_b128 v[124:127], v49
    s_waitcnt lgkmcnt(9)
    v_mfma_f32_32x32x16_bf16 v[64:79], v[92:95], v[112:115], v[64:79]
    v_add_u32 v49, s41, v19
    ds_read_b64_tr_b16 v[88:89], v63 offset:2048
    ds_read_b64_tr_b16 v[90:91], v63 offset:2560
    ds_read_b128 v[108:111], v49
    s_waitcnt lgkmcnt(9)
    v_mfma_f32_32x32x16_bf16 v[64:79], v[96:99], v[116:119], v[64:79]
    v_add_u32 v49, s41, v20
    ds_read_b64_tr_b16 v[92:93], v63 offset:4096
    ds_read_b64_tr_b16 v[94:95], v63 offset:4608
    ds_read_b128 v[112:115], v49
    s_waitcnt lgkmcnt(9)
    v_mfma_f32_32x32x16_bf16 v[64:79], v[100:103], v[120:123], v[64:79]
    v_add_u32 v49, s41, v21
    ds_read_b64_tr_b16 v[96:97], v63 offset:6144
    ds_read_b64_tr_b16 v[98:99], v63 offset:6656
    ds_read_b128 v[116:119], v49
    s_waitcnt lgkmcnt(9)
    v_mfma_f32_32x32x16_bf16 v[64:79], v[104:107], v[124:127], v[64:79]
    s_waitcnt lgkmcnt(6)
    v_mfma_f32_32x32x16_bf16 v[64:79], v[88:91], v[108:111], v[64:79]
    s_waitcnt lgkmcnt(3)
    v_mfma_f32_32x32x16_bf16 v[64:79], v[92:95], v[112:115], v[64:79]
    s_waitcnt lgkmcnt(0)
    v_mfma_f32_32x32x16_bf16 v[64:79], v[96:99], v[116:119], v[64:79]
    ds_read_b64 v[80:81], v23
    ds_read_b64 v[82:83], v24
    ds_read_b64 v[84:85], v25
    ds_read_b64 v[86:87], v26
    ds_read_b64_tr_b16 v[32:33], v27 offset:0
    ds_read_b64_tr_b16 v[34:35], v28 offset:0
    ds_read_b64_tr_b16 v[36:37], v27 offset:28672
    ds_read_b64_tr_b16 v[38:39], v28 offset:28672
    s_waitcnt vmcnt(1)
    s_barrier
    s_setprio 2
    v_lshl_add_u32 v63, s42, 3, v22
    v_add_u32 v49, s42, v18
    ds_read_b64_tr_b16 v[100:101], v63 offset:0
    ds_read_b64_tr_b16 v[102:103], v63 offset:512
    ds_read_b128 v[120:123], v49
    v_add_u32 v49, s42, v19
    ds_read_b64_tr_b16 v[104:105], v63 offset:2048
    ds_read_b64_tr_b16 v[106:107], v63 offset:2560
    ds_read_b128 v[124:127], v49
    v_add_u32 v49, s42, v20
    ds_read_b64_tr_b16 v[88:89], v63 offset:4096
    ds_read_b64_tr_b16 v[90:91], v63 offset:4608
    ds_read_b128 v[108:111], v49
    v_add_u32 v49, s42, v21
    ds_read_b64_tr_b16 v[92:93], v63 offset:6144
    ds_read_b64_tr_b16 v[94:95], v63 offset:6656
    ds_read_b128 v[112:115], v49
    s_waitcnt lgkmcnt(9)
    v_mfma_f32_32x32x16_bf16 v[64:79], v[100:103], v[120:123], v[64:79]
    v_lshl_add_u32 v63, s43, 3, v22
    v_add_u32 v49, s43, v18
    ds_read_b64_tr_b16 v[96:97], v63 offset:0
    ds_read_b64_tr_b16 v[98:99], v63 offset:512
    ds_read_b128 v[116:119], v49
    s_waitcnt lgkmcnt(9)
    v_mfma_f32_32x32x16_bf16 v[64:79], v[104:107], v[124:127], v[64:79]
    v_add_u32 v49, s43, v19
    ds_read_b64_tr_b16 v[100:101], v63 offset:2048
    ds_read_b64_tr_b16 v[102:103], v63 offset:2560
    ds_read_b128 v[120:123], v49
    s_waitcnt lgkmcnt(9)
    v_mfma_f32_32x32x16_bf16 v[64:79], v[88:91], v[108:111], v[64:79]
    v_add_u32 v49, s43, v20
    ds_read_b64_tr_b16 v[104:105], v63 offset:4096
    ds_read_b64_tr_b16 v[106:107], v63 offset:4608
    ds_read_b128 v[124:127], v49
    s_waitcnt lgkmcnt(9)
    v_mfma_f32_32x32x16_bf16 v[64:79], v[92:95], v[112:115], v[64:79]
    v_add_u32 v49, s43, v21
    ds_read_b64_tr_b16 v[88:89], v63 offset:6144
    ds_read_b64_tr_b16 v[90:91], v63 offset:6656
    ds_read_b128 v[108:111], v49
    s_waitcnt lgkmcnt(9)
    v_mfma_f32_32x32x16_bf16 v[64:79], v[96:99], v[116:119], v[64:79]
    v_lshl_add_u32 v63, s44, 3, v22
    v_add_u32 v49, s44, v18
    ds_read_b64_tr_b16 v[92:93], v63 offset:0
    ds_read_b64_tr_b16 v[94:95], v63 offset:512
    ds_read_b128 v[112:115], v49
    s_waitcnt lgkmcnt(9)
    v_mfma_f32_32x32x16_bf16 v[64:79], v[100:103], v[120:123], v[64:79]
    v_add_u32 v49, s44, v19
    ds_read_b64_tr_b16 v[96:97], v63 offset:2048
    ds_read_b64_tr_b16 v[98:99], v63 offset:2560
    ds_read_b128 v[116:119], v49
    s_waitcnt lgkmcnt(9)
    v_mfma_f32_32x32x16_bf16 v[64:79], v[104:107], v[124:127], v[64:79]
    v_add_u32 v49, s44, v20
    ds_read_b64_tr_b16 v[100:101], v63 offset:4096
    ds_read_b64_tr_b16 v[102:103], v63 offset:4608
    ds_read_b128 v[120:123], v49
    s_waitcnt lgkmcnt(9)
    v_mfma_f32_32x32x16_bf16 v[64:79], v[88:91], v[108:111], v[64:79]
    v_add_u32 v49, s44, v21
    ds_read_b64_tr_b16 v[104:105], v63 offset:6144
    ds_read_b64_tr_b16 v[106:107], v63 offset:6656
    ds_read_b128 v[124:127], v49
    s_waitcnt lgkmcnt(9)
    v_mfma_f32_32x32x16_bf16 v[64:79], v[92:95], v[112:115], v[64:79]
    v_lshl_add_u32 v63, s45, 3, v22
    v_add_u32 v49, s45, v18
    ds_read_b64_tr_b16 v[88:89], v63 offset:0
    ds_read_b64_tr_b16 v[90:91], v63 offset:512
    ds_read_b128 v[108:111], v49
    s_waitcnt lgkmcnt(9)
    v_mfma_f32_32x32x16_bf16 v[64:79], v[96:99], v[116:119], v[64:79]
    v_add_u32 v49, s45, v19
    ds_read_b64_tr_b16 v[92:93], v63 offset:2048
    ds_read_b64_tr_b16 v[94:95], v63 offset:2560
    ds_read_b128 v[112:115], v49
    s_waitcnt lgkmcnt(9)
    v_mfma_f32_32x32x16_bf16 v[64:79], v[100:103], v[120:123], v[64:79]
    v_add_u32 v49, s45, v20
    ds_read_b64_tr_b16 v[96:97], v63 offset:4096
    ds_read_b64_tr_b16 v[98:99], v63 offset:4608
    ds_read_b128 v[116:119], v49
    s_waitcnt lgkmcnt(9)
    v_mfma_f32_32x32x16_bf16 v[64:79], v[104:107], v[124:127], v[64:79]
    v_add_u32 v49, s45, v21
    ds_read_b64_tr_b16 v[100:101], v63 offset:6144
    ds_read_b64_tr_b16 v[102:103], v63 offset:6656
    ds_read_b128 v[120:123], v49
    s_waitcnt lgkmcnt(9)
    v_mfma_f32_32x32x16_bf16 v[64:79], v[88:91], v[108:111], v[64:79]
    v_lshl_add_u32 v63, s46, 3, v22
    v_add_u32 v49, s46, v18
    ds_read_b64_tr_b16 v[104:105], v63 offset:0
    ds_read_b64_tr_b16 v[106:107], v63 offset:512
    ds_read_b128 v[124:127], v49
    s_waitcnt lgkmcnt(9)
    v_mfma_f32_32x32x16_bf16 v[64:79], v[92:95], v[112:115], v[64:79]
    v_add_u32 v49, s46, v19
    ds_read_b64_tr_b16 v[88:89], v63 offset:2048
    ds_read_b64_tr_b16 v[90:91], v63 offset:2560
    ds_read_b128 v[108:111], v49
    s_waitcnt lgkmcnt(9)
    v_mfma_f32_32x32x16_bf16 v[64:79], v[96:99], v[116:119], v[64:79]
    v_add_u32 v49, s46, v20
    ds_read_b64_tr_b16 v[92:93], v63 offset:4096
    ds_read_b64_tr_b16 v[94:95], v63 offset:4608
    ds_read_b128 v[112:115], v49
    s_waitcnt lgkmcnt(9)
    v_mfma_f32_32x32x16_bf16 v[64:79], v[100:103], v[120:123], v[64:79]
    v_add_u32 v49, s46, v21
    ds_read_b64_tr_b16 v[96:97], v63 offset:6144
    ds_read_b64_tr_b16 v[98:99], v63 offset:6656
    ds_read_b128 v[116:119], v49
    s_waitcnt lgkmcnt(9)
    v_mfma_f32_32x32x16_bf16 v[64:79], v[104:107], v[124:127], v[64:79]
    s_waitcnt lgkmcnt(6)
    v_mfma_f32_32x32x16_bf16 v[64:79], v[88:91], v[108:111], v[64:79]
    s_waitcnt lgkmcnt(3)
    v_mfma_f32_32x32x16_bf16 v[64:79], v[92:95], v[112:115], v[64:79]
    s_waitcnt lgkmcnt(0)
    v_mfma_f32_32x32x16_bf16 v[64:79], v[96:99], v[116:119], v[64:79]
    s_waitcnt vmcnt(0)
    v_cmp_gt_u32 vcc, 32, v1
    v_mov_b32 v6, 163396
    s_mov_b32 s70, 0
    v_mov_b32 v5, 1
    s_mov_b64 exec, 1
    ds_add_u32 v6, v5
    s_mov_b64 exec, -1
ls_1:
    ds_read_b32 v5, v6
    s_add_u32 s70, s70, 1
    s_waitcnt lgkmcnt(0)
    v_readfirstlane_b32 s71, v5
    s_nop 0
    s_cmp_ge_u32 s71, 8
    s_nop 1
    s_cbranch_scc1 lsd_2
    s_cmp_lt_u32 s70, 3200000
    s_cbranch_scc1 ls_1
lsd_2:
    ds_read2st64_b32 v[54:55], v60 offset0:2 offset1:3
    ds_read2st64_b32 v[50:51], v61 offset0:0 offset1:1
    ds_read2st64_b32 v[52:53], v60 offset0:0 offset1:1
    ds_read_b32 v4, v62
    s_mov_b32 s12, s38
    s_and_b32 s13, s39, 0xffff
    s_mov_b32 s14, 401408
    s_mov_b32 s15, 0x20000
    s_mul_i32 s70, s51, 7
    s_mul_i32 s71, s70, 7168
    s_add_u32 s71, s71, s49
    s_lshl_b32 s70, s70, 10
    s_add_u32 m0, s70, 57344
    s_nop 0
    buffer_load_dwordx4 v8, s[12:15], s71 offen lds
    s_add_u32 s71, s71, 7168
    s_add_u32 m0, m0, 1024
    s_nop 0
    buffer_load_dwordx4 v8, s[12:15], s71 offen lds
    s_add_u32 s71, s71, 7168
    s_add_u32 m0, m0, 1024
    s_nop 0
    buffer_load_dwordx4 v8, s[12:15], s71 offen lds
    s_add_u32 s71, s71, 7168
    s_add_u32 m0, m0, 1024
    s_nop 0
    buffer_load_dwordx4 v8, s[12:15], s71 offen lds
    s_add_u32 s71, s71, 7168
    s_add_u32 m0, m0, 1024
    s_nop 0
    buffer_load_dwordx4 v8, s[12:15], s71 offen lds
    s_add_u32 s71, s71, 7168
    s_add_u32 m0, m0, 1024
    s_nop 0
    buffer_load_dwordx4 v8, s[12:15], s71 offen lds
    s_add_u32 s71, s71, 7168
    s_add_u32 m0, m0, 1024
    s_nop 0
    buffer_load_dwordx4 v8, s[12:15], s71 offen lds
    s_waitcnt lgkmcnt(3)
    v_cvt_pk_bf16_f32 v108, -v54, -v54
    v_lshlrev_b32 v92, 16, v108
    v_add_f32 v92, v54, v92
    v_cvt_pk_bf16_f32 v109, -v92, 0
    v_mov_b32 v110, 0
    v_mov_b32 v111, 0
    s_waitcnt lgkmcnt(2)
    v_add_f32 v50, v50, v51
    v_cndmask_b32 v50, 0, v50, vcc
    v_cvt_pk_bf16_f32 v92, v50, v50
    v_lshlrev_b32 v93, 16, v92
    v_sub_f32 v93, v50, v93
    v_cvt_pk_bf16_f32 v88, v50, v93
    v_and_b32 v89, 0xffff, v92
    v_mov_b32 v90, 0
    v_mov_b32 v91, 0
    s_nop 1
    v_mfma_f32_32x32x16_bf16 v[64:79], v[88:91], v[108:111], v[64:79]
    ds_read_b128 v[144:147], v47 offset:0
    ds_read_b128 v[152:155], v47 offset:256
    ds_read_b128 v[148:151], v47 offset:16
    ds_read_b128 v[156:159], v47 offset:272
    ds_read_b128 v[160:163], v47 offset:128
    ds_read_b128 v[168:171], v47 offset:384
    ds_read_b128 v[164:167], v47 offset:144
    ds_read_b128 v[172:175], v47 offset:400
    v_rcp_f32 v58, v55
    v_mul_f32 v56, 3222493025, v55
    v_mul_f32 v57, v55, v55
    v_mul_f32 v57, v57, v55
    v_mul_f32 v57, 3184710632, v57
    v_pk_mul_f32 v[92:93], v[64:65], v[64:65]
    v_pk_fma_f32 v[92:93], v[92:93], v[56:57], v[56:57] op_sel:[0,1,0] op_sel_hi:[1,1,0]
    v_pk_mul_f32 v[92:93], v[64:65], v[92:93]
    v_exp_f32 v92, v92
    v_exp_f32 v93, v93
    s_nop 0
    v_pk_fma_f32 v[92:93], v[92:93], v[58:59], v[58:59] op_sel_hi:[1,0,0]
    v_rcp_f32 v94, v92
    v_rcp_f32 v95, v93
    v_pk_mul_f32 v[96:97], v[66:67], v[66:67]
    v_pk_fma_f32 v[96:97], v[96:97], v[56:57], v[56:57] op_sel:[0,1,0] op_sel_hi:[1,1,0]
    v_pk_mul_f32 v[96:97], v[66:67], v[96:97]
    v_exp_f32 v96, v96
    v_exp_f32 v97, v97
    v_pk_mul_f32 v[94:95], v[64:65], v[94:95]
    v_cvt_pk_bf16_f32 v112, v94, v95
    v_pk_fma_f32 v[96:97], v[96:97], v[58:59], v[58:59] op_sel_hi:[1,0,0]
    v_rcp_f32 v98, v96
    v_rcp_f32 v99, v97
    v_pk_mul_f32 v[92:93], v[68:69], v[68:69]
    v_pk_fma_f32 v[92:93], v[92:93], v[56:57], v[56:57] op_sel:[0,1,0] op_sel_hi:[1,1,0]
    v_pk_mul_f32 v[92:93], v[68:69], v[92:93]
    v_exp_f32 v92, v92
    v_exp_f32 v93, v93
    v_pk_mul_f32 v[98:99], v[66:67], v[98:99]
    v_cvt_pk_bf16_f32 v113, v98, v99
    v_pk_fma_f32 v[92:93], v[92:93], v[58:59], v[58:59] op_sel_hi:[1,0,0]
    v_rcp_f32 v94, v92
    v_rcp_f32 v95, v93
    v_pk_mul_f32 v[96:97], v[70:71], v[70:71]
    v_pk_fma_f32 v[96:97], v[96:97], v[56:57], v[56:57] op_sel:[0,1,0] op_sel_hi:[1,1,0]
    v_pk_mul_f32 v[96:97], v[70:71], v[96:97]
    v_exp_f32 v96, v96
    v_exp_f32 v97, v97
    v_pk_mul_f32 v[94:95], v[68:69], v[94:95]
    v_cvt_pk_bf16_f32 v114, v94, v95
    v_pk_fma_f32 v[96:97], v[96:97], v[58:59], v[58:59] op_sel_hi:[1,0,0]
    v_rcp_f32 v98, v96
    v_rcp_f32 v99, v97
    v_pk_mul_f32 v[92:93], v[72:73], v[72:73]
    v_pk_fma_f32 v[92:93], v[92:93], v[56:57], v[56:57] op_sel:[0,1,0] op_sel_hi:[1,1,0]
    v_pk_mul_f32 v[92:93], v[72:73], v[92:93]
    v_exp_f32 v92, v92
    v_exp_f32 v93, v93
    v_pk_mul_f32 v[98:99], v[70:71], v[98:99]
    v_cvt_pk_bf16_f32 v115, v98, v99
    buffer_store_dwordx4 v[112:115], v9, s[4:7], s100 offen offset:0 sc1
    v_pk_fma_f32 v[92:93], v[92:93], v[58:59], v[58:59] op_sel_hi:[1,0,0]
    v_rcp_f32 v94, v92
    v_rcp_f32 v95, v93
    v_pk_mul_f32 v[96:97], v[74:75], v[74:75]
    v_pk_fma_f32 v[96:97], v[96:97], v[56:57], v[56:57] op_sel:[0,1,0] op_sel_hi:[1,1,0]
    v_pk_mul_f32 v[96:97], v[74:75], v[96:97]
    v_exp_f32 v96, v96
    v_exp_f32 v97, v97
    v_pk_mul_f32 v[94:95], v[72:73], v[94:95]
    v_cvt_pk_bf16_f32 v116, v94, v95
    v_pk_fma_f32 v[96:97], v[96:97], v[58:59], v[58:59] op_sel_hi:[1,0,0]
    v_rcp_f32 v98, v96
    v_rcp_f32 v99, v97
    v_pk_mul_f32 v[92:93], v[76:77], v[76:77]
    v_pk_fma_f32 v[92:93], v[92:93], v[56:57], v[56:57] op_sel:[0,1,0] op_sel_hi:[1,1,0]
    v_pk_mul_f32 v[92:93], v[76:77], v[92:93]
    v_exp_f32 v92, v92
    v_exp_f32 v93, v93
    v_pk_mul_f32 v[98:99], v[74:75], v[98:99]
    v_cvt_pk_bf16_f32 v117, v98, v99
    v_pk_fma_f32 v[92:93], v[92:93], v[58:59], v[58:59] op_sel_hi:[1,0,0]
    v_rcp_f32 v94, v92
    v_rcp_f32 v95, v93
    v_pk_mul_f32 v[96:97], v[78:79], v[78:79]
    v_pk_fma_f32 v[96:97], v[96:97], v[56:57], v[56:57] op_sel:[0,1,0] op_sel_hi:[1,1,0]
    v_pk_mul_f32 v[96:97], v[78:79], v[96:97]
    v_exp_f32 v96, v96
    v_exp_f32 v97, v97
    v_pk_mul_f32 v[94:95], v[76:77], v[94:95]
    v_cvt_pk_bf16_f32 v118, v94, v95
    v_pk_fma_f32 v[96:97], v[96:97], v[58:59], v[58:59] op_sel_hi:[1,0,0]
    v_rcp_f32 v98, v96
    v_rcp_f32 v99, v97
    s_nop 0
    v_pk_mul_f32 v[98:99], v[78:79], v[98:99]
    v_cvt_pk_bf16_f32 v119, v98, v99
    buffer_store_dwordx4 v[116:119], v9, s[4:7], s100 offen offset:1024 sc1
    s_waitcnt lgkmcnt(4)
    v_lshlrev_b32 v176, 16, v32
    v_and_b32 v177, 0xffff0000, v32
    v_pk_fma_f32 v[176:177], v[176:177], v[144:145], v[152:153]
    v_cvt_pk_bf16_f32 v32, v176, v177
    v_lshlrev_b32 v178, 16, v33
    v_and_b32 v179, 0xffff0000, v33
    v_pk_fma_f32 v[178:179], v[178:179], v[146:147], v[154:155]
    v_cvt_pk_bf16_f32 v33, v178, v179
    v_lshlrev_b32 v180, 16, v34
    v_and_b32 v181, 0xffff0000, v34
    v_pk_fma_f32 v[180:181], v[180:181], v[148:149], v[156:157]
    v_cvt_pk_bf16_f32 v34, v180, v181
    v_lshlrev_b32 v182, 16, v35
    v_and_b32 v183, 0xffff0000, v35
    v_pk_fma_f32 v[182:183], v[182:183], v[150:151], v[158:159]
    v_cvt_pk_bf16_f32 v35, v182, v183
    ds_write_b128 v45, v[32:35] offset:0
    s_waitcnt lgkmcnt(1)
    v_lshlrev_b32 v176, 16, v36
    v_and_b32 v177, 0xffff0000, v36
    v_pk_fma_f32 v[176:177], v[176:177], v[160:161], v[168:169]
    v_cvt_pk_bf16_f32 v36, v176, v177
    v_lshlrev_b32 v178, 16, v37
    v_and_b32 v179, 0xffff0000, v37
    v_pk_fma_f32 v[178:179], v[178:179], v[162:163], v[170:171]
    v_cvt_pk_bf16_f32 v37, v178, v179
    v_lshlrev_b32 v180, 16, v38
    v_and_b32 v181, 0xffff0000, v38
    v_pk_fma_f32 v[180:181], v[180:181], v[164:165], v[172:173]
    v_cvt_pk_bf16_f32 v38, v180, v181
    v_lshlrev_b32 v182, 16, v39
    v_and_b32 v183, 0xffff0000, v39
    v_pk_fma_f32 v[182:183], v[182:183], v[166:167], v[174:175]
    v_cvt_pk_bf16_f32 v39, v182, v183
    ds_write_b128 v45, v[36:39] offset:64
    ds_read_b128 v[32:35], v46 offset:0
    ds_read_b128 v[36:39], v46 offset:1152
    v_readfirstlane_b32 s50, v4
    s_nop 1
    v_mov_b32 v128, s50
    s_getreg_b32 s70, hwreg(HW_REG_XCC_ID)
    v_mov_b32 v129, s70
    v_mov_b32 v130, s50
    v_mov_b32 v131, s50
    s_waitcnt vmcnt(0)
    s_mov_b64 exec, 0xff
    buffer_store_dwordx4 v[128:131], v9, s[4:7], s92 offen sc1
    s_mov_b64 exec, -1
    s_add_u32 s70, s30, 32768
    s_waitcnt lgkmcnt(1)
    buffer_store_dwordx4 v[32:35], v48, s[4:7], s30 offen sc1
    s_waitcnt lgkmcnt(0)
    buffer_store_dwordx4 v[36:39], v48, s[4:7], s70 offen sc1
    s_waitcnt vmcnt(0)
    s_mov_b64 exec, 0xff
    buffer_store_dwordx4 v[128:131], v9, s[4:7], s31 offen sc1
    s_mov_b64 exec, -1
    v_mov_b32 v6, 163332
    v_mov_b32 v5, 1
    s_mov_b64 exec, 1
    ds_add_u32 v6, v5
    s_mov_b64 exec, -1
    s_add_u32 m0, s99, 0
    s_add_u32 s70, s101, 0
    buffer_load_dwordx4 v142, s[56:59], s70 offen lds
    s_add_u32 m0, s99, 1024
    s_add_u32 s70, s101, 57344
    buffer_load_dwordx4 v142, s[56:59], s70 offen lds
    s_add_u32 m0, s99, 2048
    s_add_u32 s70, s101, 114688
    buffer_load_dwordx4 v142, s[56:59], s70 offen lds
    s_add_u32 m0, s99, 3072
    s_add_u32 s70, s101, 172032
    buffer_load_dwordx4 v142, s[56:59], s70 offen lds
    s_add_u32 m0, s99, 4096
    s_add_u32 s70, s101, 229376
    buffer_load_dwordx4 v142, s[56:59], s70 offen lds
    s_add_u32 m0, s99, 5120
    s_add_u32 s70, s101, 286720
    buffer_load_dwordx4 v142, s[56:59], s70 offen lds
    s_add_u32 m0, s99, 6144
    s_add_u32 s70, s101, 344064
    buffer_load_dwordx4 v142, s[56:59], s70 offen lds
    s_add_u32 m0, s99, 7168
    s_add_u32 s70, s101, 401408
    buffer_load_dwordx4 v142, s[56:59], s70 offen lds
    s_add_u32 m0, s99, 8192
    s_add_u32 s70, s101, 458752
    buffer_load_dwordx4 v142, s[56:59], s70 offen lds
    s_add_u32 m0, s99, 9216
    s_add_u32 s70, s101, 516096
    buffer_load_dwordx4 v142, s[56:59], s70 offen lds
    s_waitcnt lgkmcnt(0)
    v_lshlrev_b32 v88, 16, v80
    v_and_b32 v89, 0xffff0000, v80
    v_pk_fma_f32 v[88:89], v[88:89], v[52:53], v[52:53] op_sel:[0,0,1] op_sel_hi:[1,0,1]
    v_cvt_pk_bf16_f32 v88, v88, v89
    v_and_b32 v65, 0xffff0000, v88
    v_lshlrev_b32 v64, 16, v88
    v_lshlrev_b32 v90, 16, v81
    v_and_b32 v91, 0xffff0000, v81
    v_pk_fma_f32 v[90:91], v[90:91], v[52:53], v[52:53] op_sel:[0,0,1] op_sel_hi:[1,0,1]
    v_cvt_pk_bf16_f32 v90, v90, v91
    v_and_b32 v67, 0xffff0000, v90
    v_lshlrev_b32 v66, 16, v90
    v_lshlrev_b32 v92, 16, v82
    v_and_b32 v93, 0xffff0000, v82
    v_pk_fma_f32 v[92:93], v[92:93], v[52:53], v[52:53] op_sel:[0,0,1] op_sel_hi:[1,0,1]
    v_cvt_pk_bf16_f32 v92, v92, v93
    v_and_b32 v69, 0xffff0000, v92
    v_lshlrev_b32 v68, 16, v92
    v_lshlrev_b32 v94, 16, v83
    v_and_b32 v95, 0xffff0000, v83
    v_pk_fma_f32 v[94:95], v[94:95], v[52:53], v[52:53] op_sel:[0,0,1] op_sel_hi:[1,0,1]
    v_cvt_pk_bf16_f32 v94, v94, v95
    v_and_b32 v71, 0xffff0000, v94
    v_lshlrev_b32 v70, 16, v94
    v_lshlrev_b32 v88, 16, v84
    v_and_b32 v89, 0xffff0000, v84
    v_pk_fma_f32 v[88:89], v[88:89], v[52:53], v[52:53] op_sel:[0,0,1] op_sel_hi:[1,0,1]
    v_cvt_pk_bf16_f32 v88, v88, v89
    v_and_b32 v73, 0xffff0000, v88
    v_lshlrev_b32 v72, 16, v88
    v_lshlrev_b32 v90, 16, v85
    v_and_b32 v91, 0xffff0000, v85
    v_pk_fma_f32 v[90:91], v[90:91], v[52:53], v[52:53] op_sel:[0,0,1] op_sel_hi:[1,0,1]
    v_cvt_pk_bf16_f32 v90, v90, v91
    v_and_b32 v75, 0xffff0000, v90
    v_lshlrev_b32 v74, 16, v90
    v_lshlrev_b32 v92, 16, v86
    v_and_b32 v93, 0xffff0000, v86
    v_pk_fma_f32 v[92:93], v[92:93], v[52:53], v[52:53] op_sel:[0,0,1] op_sel_hi:[1,0,1]
    v_cvt_pk_bf16_f32 v92, v92, v93
    v_and_b32 v77, 0xffff0000, v92
    v_lshlrev_b32 v76, 16, v92
    v_lshlrev_b32 v94, 16, v87
    v_and_b32 v95, 0xffff0000, v87
    v_pk_fma_f32 v[94:95], v[94:95], v[52:53], v[52:53] op_sel:[0,0,1] op_sel_hi:[1,0,1]
    v_cvt_pk_bf16_f32 v94, v94, v95
    v_and_b32 v79, 0xffff0000, v94
    v_lshlrev_b32 v78, 16, v94
    s_setprio 0
    s_lshl_b32 s70, s65, 3
    s_add_u32 s70, s70, s51
    s_lshl_b32 s40, s70, 9
    s_mul_i32 s71, s40, 56
    s_add_u32 s2, s71, 20971520
    s_add_u32 s40, s40, 327680
    s_sub_u32 s36, s2, 2097152
    s_sub_u32 s37, s2, 2089984
    s_sub_u32 s38, s2, 2082816
    s_sub_u32 s39, s2, 2075648
    s_lshl_b32 s47, s95, 2
    s_add_u32 s47, s47, 163376
    s_mov_b32 exec_lo, s27
    s_mov_b32 exec_hi, s28
    s_mov_b32 s71, 0
    buffer_load_dwordx2 v[18:19], v31, s[4:7], 0 offen sc1
    s_mov_b64 exec, -1
    v_mov_b32 v6, 163332
    s_mov_b32 s70, 0
ls_6:
    ds_read_b32 v5, v6
    s_add_u32 s70, s70, 1
    s_waitcnt lgkmcnt(0)
    v_readfirstlane_b32 s71, v5
    s_nop 0
    s_cmp_ge_u32 s71, 8
    s_nop 1
    s_cbranch_scc1 lsd_7
    s_cmp_lt_u32 s70, 3200000
    s_cbranch_scc1 ls_6
lsd_7:
    ds_read_b64_tr_b16 v[80:81], v29 offset:0
    ds_read_b64_tr_b16 v[82:83], v29 offset:1024
    ds_read_b64_tr_b16 v[84:85], v30 offset:0
    ds_read_b64_tr_b16 v[86:87], v30 offset:1024
    ds_read_b64_tr_b16 v[88:89], v29 offset:2048
    ds_read_b64_tr_b16 v[90:91], v29 offset:3072
    ds_read_b64_tr_b16 v[92:93], v30 offset:2048
    ds_read_b64_tr_b16 v[94:95], v30 offset:3072
    ds_read_b64_tr_b16 v[96:97], v29 offset:4096
    ds_read_b64_tr_b16 v[98:99], v29 offset:5120
    ds_read_b64_tr_b16 v[100:101], v30 offset:4096
    ds_read_b64_tr_b16 v[102:103], v30 offset:5120
    ds_read_b64_tr_b16 v[104:105], v29 offset:6144
    ds_read_b64_tr_b16 v[106:107], v29 offset:7168
    ds_read_b64_tr_b16 v[108:109], v30 offset:6144
    ds_read_b64_tr_b16 v[110:111], v30 offset:7168
    s_mov_b32 exec_lo, s27
    s_mov_b32 exec_hi, s28
    s_mov_b32 s71, 0
    s_waitcnt vmcnt(0)
    s_branch pollc_5
poll_3:
    buffer_load_dwordx2 v[18:19], v31, s[4:7], 0 offen sc1
    s_add_u32 s71, s71, 1
    s_waitcnt vmcnt(0)
pollc_5:
    v_cmp_ne_u32 vcc, s50, v18
    s_nop 3
    s_cbranch_vccz polld_4
    s_cmp_lt_u32 s71, 400000
    s_cbranch_scc1 poll_3
polld_4:
    s_mov_b64 exec, -1
    s_setprio 2
    buffer_load_dwordx4 v[200:203], v40, s[4:7], s24 offen offset:0 sc1
    buffer_load_dwordx4 v[204:207], v40, s[4:7], s24 offen offset:1024 sc1
    buffer_load_dwordx4 v[208:211], v40, s[4:7], s24 offen offset:2048 sc1
    buffer_load_dwordx4 v[212:215], v40, s[4:7], s24 offen offset:3072 sc1
    buffer_load_dwordx4 v[216:219], v40, s[4:7], s25 offen offset:0 sc1
    buffer_load_dwordx4 v[220:223], v40, s[4:7], s25 offen offset:1024 sc1
    buffer_load_dwordx4 v[224:227], v40, s[4:7], s25 offen offset:2048 sc1
    buffer_load_dwordx4 v[228:231], v41, s[4:7], s24 offen offset:0 sc1
    buffer_load_dwordx4 v[232:235], v41, s[4:7], s24 offen offset:1024 sc1
    buffer_load_dwordx4 v[236:239], v41, s[4:7], s24 offen offset:2048 sc1
    buffer_load_dwordx4 v[240:243], v41, s[4:7], s24 offen offset:3072 sc1
    buffer_load_dwordx4 v[244:247], v41, s[4:7], s25 offen offset:0 sc1
    buffer_load_dwordx4 v[248:251], v41, s[4:7], s25 offen offset:1024 sc1
    buffer_load_dwordx4 v[252:255], v41, s[4:7], s25 offen offset:2048 sc1
    v_cmp_ne_u32 vcc, v129, v19
    s_nop 0
    s_and_b32 s70, vcc_lo, 0x0FFFC000
    s_cmp_eq_u32 s70, 0
    s_cselect_b32 s33, 0, 0
    v_mov_b32 v6, 163456
    v_mov_b32 v5, s33
    ds_write_b32 v6, v5
    v_mov_b32 v6, 163404
    v_mov_b32 v5, 1
    s_mov_b64 exec, 1
    ds_add_u32 v6, v5
    s_mov_b64 exec, -1
    ds_read_b64_tr_b16 v[144:145], v134 offset:0
    ds_read_b64_tr_b16 v[146:147], v134 offset:512
    ds_read_b64_tr_b16 v[148:149], v134 offset:1024
    ds_read_b64_tr_b16 v[150:151], v134 offset:1536
    ds_read_b64_tr_b16 v[152:153], v134 offset:2048
    ds_read_b64_tr_b16 v[154:155], v134 offset:2560
    ds_read_b64_tr_b16 v[156:157], v134 offset:3072
    ds_read_b64_tr_b16 v[158:159], v134 offset:3584
    ds_read_b64_tr_b16 v[160:161], v134 offset:4096
    ds_read_b64_tr_b16 v[162:163], v134 offset:4608
    ds_read_b64_tr_b16 v[164:165], v134 offset:5120
    ds_read_b64_tr_b16 v[166:167], v134 offset:5632
    ds_read_b64_tr_b16 v[168:169], v134 offset:6144
    ds_read_b64_tr_b16 v[170:171], v134 offset:6656
    ds_read_b64_tr_b16 v[172:173], v134 offset:7168
    ds_read_b64_tr_b16 v[174:175], v134 offset:7680
    ds_read_b64_tr_b16 v[176:177], v134 offset:8192
    ds_read_b64_tr_b16 v[178:179], v134 offset:8704
    ds_read_b64_tr_b16 v[180:181], v134 offset:9216
    ds_read_b64_tr_b16 v[182:183], v134 offset:9728
    s_waitcnt lgkmcnt(10)
    s_add_u32 m0, s99, 4096
    s_add_u32 s70, s101, 573440
    buffer_load_dwordx4 v142, s[56:59], s70 offen lds
    s_waitcnt lgkmcnt(8)
    s_add_u32 m0, s99, 5120
    s_add_u32 s70, s101, 630784
    buffer_load_dwordx4 v142, s[56:59], s70 offen lds
    s_waitcnt lgkmcnt(6)
    s_add_u32 m0, s99, 6144
    s_add_u32 s70, s101, 688128
    buffer_load_dwordx4 v142, s[56:59], s70 offen lds
    s_waitcnt lgkmcnt(4)
    s_add_u32 m0, s99, 7168
    s_add_u32 s70, s101, 745472
    buffer_load_dwordx4 v142, s[56:59], s70 offen lds
    s_waitcnt lgkmcnt(2)
    s_add_u32 m0, s99, 8192
    s_add_u32 s70, s101, 802816
    buffer_load_dwordx4 v142, s[56:59], s70 offen lds
    s_waitcnt lgkmcnt(0)
    s_add_u32 m0, s99, 9216
    s_add_u32 s70, s101, 860160
    buffer_load_dwordx4 v142, s[56:59], s70 offen lds
    s_mul_i32 s70, s3, 224
    s_mul_i32 s71, s51, 56
    s_add_u32 s70, s70, s71
    v_add_u32 v5, s70, v1
    v_mul_u32_u24 v6, 18725, v5
    v_lshrrev_b32 v6, 24, v6
    v_mul_u32_u24 v6, 896, v6
    v_add_lshl_u32 v5, v5, v6, 7
    s_mov_b32 s70, 18989056
    buffer_load_dword v140, v5, s[4:7], s70 offen sc1
    s_waitcnt vmcnt(20)
    v_mfma_f32_32x32x16_bf16 v[48:63], v[84:87], v[200:203], 0
    v_mfma_f32_32x32x16_bf16 v[64:79], v[80:83], v[200:203], v[64:79]
    ds_read_b64_tr_b16 v[80:81], v29 offset:8192
    ds_read_b64_tr_b16 v[82:83], v29 offset:9216
    ds_read_b64_tr_b16 v[84:85], v30 offset:8192
    ds_read_b64_tr_b16 v[86:87], v30 offset:9216
    s_waitcnt vmcnt(19)
    v_mfma_f32_32x32x16_bf16 v[48:63], v[92:95], v[204:207], v[48:63]
    v_mfma_f32_32x32x16_bf16 v[64:79], v[88:91], v[204:207], v[64:79]
    ds_read_b64_tr_b16 v[88:89], v29 offset:10240
    ds_read_b64_tr_b16 v[90:91], v29 offset:11264
    ds_read_b64_tr_b16 v[92:93], v30 offset:10240
    ds_read_b64_tr_b16 v[94:95], v30 offset:11264
    s_waitcnt vmcnt(18)
    v_mfma_f32_32x32x16_bf16 v[48:63], v[100:103], v[208:211], v[48:63]
    v_mfma_f32_32x32x16_bf16 v[64:79], v[96:99], v[208:211], v[64:79]
    ds_read_b64_tr_b16 v[96:97], v29 offset:12288
    ds_read_b64_tr_b16 v[98:99], v29 offset:13312
    ds_read_b64_tr_b16 v[100:101], v30 offset:12288
    ds_read_b64_tr_b16 v[102:103], v30 offset:13312
    s_waitcnt vmcnt(17)
    v_mfma_f32_32x32x16_bf16 v[48:63], v[108:111], v[212:215], v[48:63]
    v_mfma_f32_32x32x16_bf16 v[64:79], v[104:107], v[212:215], v[64:79]
    ds_read_b64_tr_b16 v[104:105], v29 offset:14336
    ds_read_b64_tr_b16 v[106:107], v29 offset:15360
    ds_read_b64_tr_b16 v[108:109], v30 offset:14336
    ds_read_b64_tr_b16 v[110:111], v30 offset:15360
    s_waitcnt vmcnt(16)
    s_waitcnt lgkmcnt(12)
    v_mfma_f32_32x32x16_bf16 v[48:63], v[84:87], v[216:219], v[48:63]
    v_mfma_f32_32x32x16_bf16 v[64:79], v[80:83], v[216:219], v[64:79]
    ds_read_b64_tr_b16 v[80:81], v29 offset:16384
    ds_read_b64_tr_b16 v[82:83], v29 offset:17408
    ds_read_b64_tr_b16 v[84:85], v30 offset:16384
    ds_read_b64_tr_b16 v[86:87], v30 offset:17408
    s_waitcnt vmcnt(15)
    s_waitcnt lgkmcnt(12)
    v_mfma_f32_32x32x16_bf16 v[48:63], v[92:95], v[220:223], v[48:63]
    v_mfma_f32_32x32x16_bf16 v[64:79], v[88:91], v[220:223], v[64:79]
    ds_read_b64_tr_b16 v[88:89], v29 offset:18432
    ds_read_b64_tr_b16 v[90:91], v29 offset:19456
    ds_read_b64_tr_b16 v[92:93], v30 offset:18432
    ds_read_b64_tr_b16 v[94:95], v30 offset:19456
    s_waitcnt vmcnt(14)
    s_waitcnt lgkmcnt(12)
    v_mfma_f32_32x32x16_bf16 v[48:63], v[100:103], v[224:227], v[48:63]
    v_mfma_f32_32x32x16_bf16 v[64:79], v[96:99], v[224:227], v[64:79]
    ds_read_b64_tr_b16 v[96:97], v29 offset:20480
    ds_read_b64_tr_b16 v[98:99], v29 offset:21504
    ds_read_b64_tr_b16 v[100:101], v30 offset:20480
    ds_read_b64_tr_b16 v[102:103], v30 offset:21504
    s_waitcnt vmcnt(13)
    s_waitcnt lgkmcnt(12)
    v_mfma_f32_32x32x16_bf16 v[48:63], v[108:111], v[228:231], v[48:63]
    v_mfma_f32_32x32x16_bf16 v[64:79], v[104:107], v[228:231], v[64:79]
    ds_read_b64_tr_b16 v[104:105], v29 offset:22528
    ds_read_b64_tr_b16 v[106:107], v29 offset:23552
    ds_read_b64_tr_b16 v[108:109], v30 offset:22528
    ds_read_b64_tr_b16 v[110:111], v30 offset:23552
    s_waitcnt vmcnt(12)
    s_waitcnt lgkmcnt(12)
    v_mfma_f32_32x32x16_bf16 v[48:63], v[84:87], v[232:235], v[48:63]
    v_mfma_f32_32x32x16_bf16 v[64:79], v[80:83], v[232:235], v[64:79]
    ds_read_b64_tr_b16 v[80:81], v29 offset:24576
    ds_read_b64_tr_b16 v[82:83], v29 offset:25600
    ds_read_b64_tr_b16 v[84:85], v30 offset:24576
    ds_read_b64_tr_b16 v[86:87], v30 offset:25600
    s_waitcnt vmcnt(11)
    s_waitcnt lgkmcnt(12)
    v_mfma_f32_32x32x16_bf16 v[48:63], v[92:95], v[236:239], v[48:63]
    v_mfma_f32_32x32x16_bf16 v[64:79], v[88:91], v[236:239], v[64:79]
    ds_read_b64_tr_b16 v[88:89], v29 offset:26624
    ds_read_b64_tr_b16 v[90:91], v29 offset:27648
    ds_read_b64_tr_b16 v[92:93], v30 offset:26624
    ds_read_b64_tr_b16 v[94:95], v30 offset:27648
    s_waitcnt vmcnt(10)
    s_waitcnt lgkmcnt(12)
    v_mfma_f32_32x32x16_bf16 v[48:63], v[100:103], v[240:243], v[48:63]
    v_mfma_f32_32x32x16_bf16 v[64:79], v[96:99], v[240:243], v[64:79]
    s_waitcnt vmcnt(9)
    s_waitcnt lgkmcnt(8)
    v_mfma_f32_32x32x16_bf16 v[48:63], v[108:111], v[244:247], v[48:63]
    v_mfma_f32_32x32x16_bf16 v[64:79], v[104:107], v[244:247], v[64:79]
    s_waitcnt vmcnt(8)
    s_waitcnt lgkmcnt(4)
    v_mfma_f32_32x32x16_bf16 v[48:63], v[84:87], v[248:251], v[48:63]
    v_mfma_f32_32x32x16_bf16 v[64:79], v[80:83], v[248:251], v[64:79]
    s_waitcnt vmcnt(7)
    s_waitcnt lgkmcnt(0)
    v_mfma_f32_32x32x16_bf16 v[48:63], v[92:95], v[252:255], v[48:63]
    v_mfma_f32_32x32x16_bf16 v[64:79], v[88:91], v[252:255], v[64:79]
    s_nop 10
    ds_write_b128 v42, v[48:51] offset:0
    ds_write_b128 v42, v[52:55] offset:1024
    ds_write_b128 v42, v[56:59] offset:2048
    ds_write_b128 v42, v[60:63] offset:3072
    s_waitcnt lgkmcnt(0)
    v_mov_b32 v6, s47
    s_mov_b32 s70, 0
    v_mov_b32 v5, 1
    s_mov_b64 exec, 1
    ds_add_u32 v6, v5
    s_mov_b64 exec, -1
ls_8:
    ds_read_b32 v5, v6
    s_add_u32 s70, s70, 1
    s_waitcnt lgkmcnt(0)
    v_readfirstlane_b32 s71, v5
    s_nop 0
    s_cmp_ge_u32 s71, 2
    s_nop 1
    s_cbranch_scc1 lsd_9
    s_cmp_lt_u32 s70, 3200000
    s_cbranch_scc1 ls_8
lsd_9:
    ds_read_b128 v[48:51], v43 offset:0
    ds_read_b128 v[52:55], v43 offset:1024
    ds_read_b128 v[56:59], v43 offset:2048
    ds_read_b128 v[60:63], v43 offset:3072
    s_add_u32 s100, s93, 3145728
    s_waitcnt lgkmcnt(3)
    v_add_f32 v64, v64, v48
    v_add_f32 v65, v65, v49
    v_cvt_pk_bf16_f32 v200, v64, v65
    v_add_f32 v66, v66, v50
    v_add_f32 v67, v67, v51
    v_cvt_pk_bf16_f32 v201, v66, v67
    s_waitcnt lgkmcnt(2)
    v_add_f32 v68, v68, v52
    v_add_f32 v69, v69, v53
    v_cvt_pk_bf16_f32 v202, v68, v69
    v_add_f32 v70, v70, v54
    v_add_f32 v71, v71, v55
    v_cvt_pk_bf16_f32 v203, v70, v71
    buffer_store_dwordx4 v[200:203], v9, s[4:7], s100 offen offset:0 sc1
    s_waitcnt lgkmcnt(1)
    v_add_f32 v72, v72, v56
    v_add_f32 v73, v73, v57
    v_cvt_pk_bf16_f32 v204, v72, v73
    v_add_f32 v74, v74, v58
    v_add_f32 v75, v75, v59
    v_cvt_pk_bf16_f32 v205, v74, v75
    s_waitcnt lgkmcnt(0)
    v_add_f32 v76, v76, v60
    v_add_f32 v77, v77, v61
    v_cvt_pk_bf16_f32 v206, v76, v77
    v_add_f32 v78, v78, v62
    v_add_f32 v79, v79, v63
    v_cvt_pk_bf16_f32 v207, v78, v79
    buffer_store_dwordx4 v[204:207], v9, s[4:7], s100 offen offset:1024 sc1
    v_mov_b32 v208, 0
    v_mov_b32 v209, 0
    s_mov_b32 s71, 0x3f803f80
    v_dot2_f32_bf16 v208, v200, s71, v208
    v_dot2_f32_bf16 v209, v200, v200, v209
    v_dot2_f32_bf16 v208, v201, s71, v208
    v_dot2_f32_bf16 v209, v201, v201, v209
    v_dot2_f32_bf16 v208, v202, s71, v208
    v_dot2_f32_bf16 v209, v202, v202, v209
    v_dot2_f32_bf16 v208, v203, s71, v208
    v_dot2_f32_bf16 v209, v203, v203, v209
    v_dot2_f32_bf16 v208, v204, s71, v208
    v_dot2_f32_bf16 v209, v204, v204, v209
    v_dot2_f32_bf16 v208, v205, s71, v208
    v_dot2_f32_bf16 v209, v205, v205, v209
    v_dot2_f32_bf16 v208, v206, s71, v208
    v_dot2_f32_bf16 v209, v206, v206, v209
    v_dot2_f32_bf16 v208, v207, s71, v208
    v_dot2_f32_bf16 v209, v207, v207, v209
    s_nop 1
    v_mov_b32 v210, v208
    v_mov_b32 v211, v209
    s_mul_i32 s70, s29, 14
    s_lshl_b32 s71, s65, 1
    v_permlane32_swap_b32 v210, v208
    v_permlane32_swap_b32 v211, v209
    s_add_u32 s70, s70, s71
    s_add_u32 s70, s70, s94
    v_add_f32 v208, v208, v210
    v_add_f32 v209, v209, v211
    s_lshl_b32 s70, s70, 8
    s_add_u32 s70, s70, 65536
    v_lshlrev_b32 v5, 3, v1
    s_mov_b32 exec_hi, 0
    buffer_store_dwordx2 v[208:209], v5, s[4:7], s70 offen offset:0 sc1
    s_mov_b32 exec_hi, -1
    s_mul_i32 s100, s66, 3584
    s_add_u32 s100, s100, 17956864
    s_add_u32 s47, s47, 8
    v_mov_b32 v6, s47
    s_mov_b32 s70, 0
    v_mov_b32 v5, 1
    s_mov_b64 exec, 1
    ds_add_u32 v6, v5
    s_mov_b64 exec, -1
ls_10:
    ds_read_b32 v5, v6
    s_add_u32 s70, s70, 1
    s_waitcnt lgkmcnt(0)
    v_readfirstlane_b32 s71, v5
    s_nop 0
    s_cmp_ge_u32 s71, 2
    s_nop 1
    s_cbranch_scc1 lsd_11
    s_cmp_lt_u32 s70, 3200000
    s_cbranch_scc1 ls_10
lsd_11:
    s_add_u32 m0, s99, 0
    s_add_u32 s70, s101, 917504
    buffer_load_dwordx4 v142, s[56:59], s70 offen lds
    s_add_u32 m0, s99, 1024
    s_add_u32 s70, s101, 974848
    buffer_load_dwordx4 v142, s[56:59], s70 offen lds
    s_add_u32 m0, s99, 2048
    s_add_u32 s70, s101, 1032192
    buffer_load_dwordx4 v142, s[56:59], s70 offen lds
    s_add_u32 m0, s99, 3072
    s_add_u32 s70, s101, 1089536
    buffer_load_dwordx4 v142, s[56:59], s70 offen lds
    s_waitcnt vmcnt(13)
    ds_read_b64_tr_b16 v[184:185], v134 offset:4096
    ds_read_b64_tr_b16 v[186:187], v134 offset:4608
    s_waitcnt vmcnt(12)
    ds_read_b64_tr_b16 v[188:189], v134 offset:5120
    ds_read_b64_tr_b16 v[190:191], v134 offset:5632
    s_waitcnt vmcnt(11)
    ds_read_b64_tr_b16 v[192:193], v134 offset:6144
    ds_read_b64_tr_b16 v[194:195], v134 offset:6656
    s_waitcnt vmcnt(10)
    ds_read_b64_tr_b16 v[196:197], v134 offset:7168
    ds_read_b64_tr_b16 v[198:199], v134 offset:7680
    s_waitcnt vmcnt(9)
    ds_read_b64_tr_b16 v[200:201], v134 offset:8192
    ds_read_b64_tr_b16 v[202:203], v134 offset:8704
    s_waitcnt vmcnt(8)
    ds_read_b64_tr_b16 v[204:205], v134 offset:9216
    ds_read_b64_tr_b16 v[206:207], v134 offset:9728
    s_waitcnt vmcnt(4)
    s_mov_b64 exec, 0xff
    buffer_store_dwordx4 v[128:131], v9, s[4:7], s32 offen sc1
    s_mov_b64 exec, -1
    s_waitcnt lgkmcnt(10)
    s_add_u32 m0, s99, 4096
    s_add_u32 s70, s101, 1146880
    buffer_load_dwordx4 v142, s[56:59], s70 offen lds
    s_waitcnt lgkmcnt(8)
    s_add_u32 m0, s99, 5120
    s_add_u32 s70, s101, 1204224
    buffer_load_dwordx4 v142, s[56:59], s70 offen lds
    s_waitcnt lgkmcnt(6)
    s_add_u32 m0, s99, 6144
    s_add_u32 s70, s101, 1261568
    buffer_load_dwordx4 v142, s[56:59], s70 offen lds
    s_waitcnt lgkmcnt(4)
    s_add_u32 m0, s99, 7168
    s_add_u32 s70, s101, 1318912
    buffer_load_dwordx4 v142, s[56:59], s70 offen lds
    s_waitcnt lgkmcnt(2)
    s_add_u32 m0, s99, 8192
    s_add_u32 s70, s101, 1376256
    buffer_load_dwordx4 v142, s[56:59], s70 offen lds
    s_waitcnt lgkmcnt(0)
    s_add_u32 m0, s99, 9216
    s_add_u32 s70, s101, 1433600
    buffer_load_dwordx4 v142, s[56:59], s70 offen lds
    s_waitcnt vmcnt(10)
    ds_read_b64_tr_b16 v[208:209], v134 offset:0
    ds_read_b64_tr_b16 v[210:211], v134 offset:512
    s_waitcnt vmcnt(9)
    ds_read_b64_tr_b16 v[212:213], v134 offset:1024
    ds_read_b64_tr_b16 v[214:215], v134 offset:1536
    s_waitcnt vmcnt(8)
    ds_read_b64_tr_b16 v[216:217], v134 offset:2048
    ds_read_b64_tr_b16 v[218:219], v134 offset:2560
    s_waitcnt vmcnt(7)
    ds_read_b64_tr_b16 v[220:221], v134 offset:3072
    ds_read_b64_tr_b16 v[222:223], v134 offset:3584
    s_waitcnt lgkmcnt(6)
    s_add_u32 m0, s99, 0
    s_add_u32 s70, s101, 1490944
    buffer_load_dwordx4 v142, s[56:59], s70 offen lds
    s_waitcnt lgkmcnt(4)
    s_add_u32 m0, s99, 1024
    s_add_u32 s70, s101, 1548288
    buffer_load_dwordx4 v142, s[56:59], s70 offen lds
    s_mov_b32 s70, 20971520
    buffer_load_dword v140, v44, s[4:7], s70 offen sc1
    s_setprio 0
    v_lshlrev_b32 v12, 7, v1
    v_mov_b32 v7, v12
    s_lshl_b32 s47, s65, 12
    s_add_u32 s47, s47, 16936960
    v_add_u32 v12, s100, v12
    v_lshlrev_b32 v13, 7, v1
    s_add_u32 s70, s40, 16577024
    v_add_u32 v13, s70, v13
    s_mov_b32 s70, 0xF0000000
    s_mov_b32 s71, 0
    v_cndmask_b32 v12, v12, v13, s[70:71]
    s_and_b32 s70, s51, 1
    s_mul_i32 s70, s70, 28
    s_lshr_b32 s71, s51, 1
    s_mul_i32 s71, s71, 14
    s_add_u32 s70, s70, s71
    s_lshl_b32 s44, s70, 10
    s_mul_i32 s45, s66, 57344
    s_add_u32 s45, s45, s44
    s_add_u32 s45, s45, 3145728
    s_add_u32 s44, s44, 57344
    v_and_b32 v13, 15, v1
    v_lshlrev_b32 v13, 3, v13
    v_lshrrev_b32 v14, 4, v1
    v_lshl_add_u32 v13, v14, 8, v13
    s_lshl_b32 s70, s66, 1
    s_lshr_b32 s71, s51, 1
    s_add_u32 s70, s70, s71
    s_mul_i32 s46, s70, 3584
    s_and_b32 s71, s51, 1
    s_lshl_b32 s71, s71, 7
    s_add_u32 s46, s46, s71
    s_add_u32 s46, s46, 65536
    v_cmp_gt_u32 vcc, 32, v1
    v_mov_b32 v14, 1073741824
    s_nop 0
    v_cndmask_b32 v14, v14, v13, vcc
    s_mov_b32 exec_lo, -1
    s_mov_b32 exec_hi, 0
    s_mov_b32 s71, 0
poll_12:
    buffer_load_dword v2, v12, s[4:7], 0 offen sc1
    s_add_u32 s71, s71, 1
    s_waitcnt vmcnt(0)
    v_cmp_ne_u32 vcc, s50, v2
    s_nop 3
    s_cbranch_vccz polld_13
    s_cmp_lt_u32 s71, 400000
    s_cbranch_scc1 poll_12
polld_13:
    s_mov_b64 exec, -1
    v_mov_b32 v5, v13
    v_mov_b32 v6, v14
    buffer_load_dwordx2 v[12:13], v5, s[4:7], s46 offen offset:0 sc1
    buffer_load_dwordx2 v[14:15], v5, s[4:7], s46 offen offset:1024 sc1
    buffer_load_dwordx2 v[16:17], v5, s[4:7], s46 offen offset:2048 sc1
    buffer_load_dwordx2 v[18:19], v6, s[4:7], s46 offen offset:3072 sc1
    s_lshl_b32 s70, s65, 11
    s_add_u32 m0, s44, s70
    s_add_u32 s71, s45, s70
    buffer_load_dwordx4 v9, s[4:7], s71 offen sc1 lds
    s_add_u32 s70, s70, 1024
    s_cmp_eq_u32 s70, 14336
    s_cselect_b32 s70, 0, s70
    s_add_u32 m0, s44, s70
    s_add_u32 s71, s45, s70
    buffer_load_dwordx4 v9, s[4:7], s71 offen sc1 lds
    s_add_u32 s70, s70, 1024
    s_cmp_eq_u32 s70, 14336
    s_cselect_b32 s70, 0, s70
    s_add_u32 m0, s44, s70
    s_add_u32 s71, s45, s70
    buffer_load_dwordx4 v9, s[4:7], s71 offen sc1 lds
    s_add_u32 s70, s70, 1024
    s_cmp_eq_u32 s70, 14336
    s_cselect_b32 s70, 0, s70
    s_add_u32 m0, s44, s70
    s_add_u32 s71, s45, s70
    buffer_load_dwordx4 v9, s[4:7], s71 offen sc1 lds
    s_add_u32 s70, s70, 1024
    s_cmp_eq_u32 s70, 14336
    s_cselect_b32 s70, 0, s70
    s_add_u32 m0, s44, s70
    s_add_u32 s71, s45, s70
    buffer_load_dwordx4 v9, s[4:7], s71 offen sc1 lds
    s_add_u32 s70, s70, 1024
    s_cmp_eq_u32 s70, 14336
    s_cselect_b32 s70, 0, s70
    s_add_u32 m0, s44, s70
    s_add_u32 s71, s45, s70
    buffer_load_dwordx4 v9, s[4:7], s71 offen sc1 lds
    s_add_u32 s70, s70, 1024
    s_cmp_eq_u32 s70, 14336
    s_cselect_b32 s70, 0, s70
    s_add_u32 m0, s44, s70
    s_add_u32 s71, s45, s70
    buffer_load_dwordx4 v9, s[4:7], s71 offen sc1 lds
    s_add_u32 s70, s70, 1024
    s_cmp_eq_u32 s70, 14336
    s_cselect_b32 s70, 0, s70
    s_add_u32 m0, s44, s70
    s_add_u32 s71, s45, s70
    buffer_load_dwordx4 v9, s[4:7], s71 offen sc1 lds
    s_add_u32 s70, s70, 1024
    s_cmp_eq_u32 s70, 14336
    s_cselect_b32 s70, 0, s70
    s_add_u32 m0, s44, s70
    s_add_u32 s71, s45, s70
    buffer_load_dwordx4 v9, s[4:7], s71 offen sc1 lds
    s_add_u32 s70, s70, 1024
    s_cmp_eq_u32 s70, 14336
    s_cselect_b32 s70, 0, s70
    s_add_u32 m0, s44, s70
    s_add_u32 s71, s45, s70
    buffer_load_dwordx4 v9, s[4:7], s71 offen sc1 lds
    s_add_u32 s70, s70, 1024
    s_cmp_eq_u32 s70, 14336
    s_cselect_b32 s70, 0, s70
    s_add_u32 m0, s44, s70
    s_add_u32 s71, s45, s70
    buffer_load_dwordx4 v9, s[4:7], s71 offen sc1 lds
    s_add_u32 s70, s70, 1024
    s_cmp_eq_u32 s70, 14336
    s_cselect_b32 s70, 0, s70
    s_add_u32 m0, s44, s70
    s_add_u32 s71, s45, s70
    buffer_load_dwordx4 v9, s[4:7], s71 offen sc1 lds
    s_add_u32 s70, s70, 1024
    s_cmp_eq_u32 s70, 14336
    s_cselect_b32 s70, 0, s70
    s_add_u32 m0, s44, s70
    s_add_u32 s71, s45, s70
    buffer_load_dwordx4 v9, s[4:7], s71 offen sc1 lds
    s_add_u32 s70, s70, 1024
    s_cmp_eq_u32 s70, 14336
    s_cselect_b32 s70, 0, s70
    s_add_u32 m0, s44, s70
    s_add_u32 s71, s45, s70
    buffer_load_dwordx4 v9, s[4:7], s71 offen sc1 lds
    v_lshlrev_b32 v5, 2, v1
    buffer_load_dword v132, v5, s[4:7], s40 offen sc1
    buffer_load_dword v133, v5, s[4:7], s40 offen offset:256 sc1
    ds_read_b64_tr_b16 v[224:225], v134 offset:4096
    ds_read_b64_tr_b16 v[226:227], v134 offset:4608
    ds_read_b64_tr_b16 v[228:229], v134 offset:5120
    ds_read_b64_tr_b16 v[230:231], v134 offset:5632
    ds_read_b64_tr_b16 v[232:233], v134 offset:6144
    ds_read_b64_tr_b16 v[234:235], v134 offset:6656
    ds_read_b64_tr_b16 v[236:237], v134 offset:7168
    ds_read_b64_tr_b16 v[238:239], v134 offset:7680
    ds_read_b64_tr_b16 v[240:241], v134 offset:8192
    ds_read_b64_tr_b16 v[242:243], v134 offset:8704
    ds_read_b64_tr_b16 v[244:245], v134 offset:9216
    ds_read_b64_tr_b16 v[246:247], v134 offset:9728
    ds_read_b64_tr_b16 v[248:249], v134 offset:0
    ds_read_b64_tr_b16 v[250:251], v134 offset:512
    ds_read_b64_tr_b16 v[252:253], v134 offset:1024
    ds_read_b64_tr_b16 v[254:255], v134 offset:1536
    s_mov_b32 exec_lo, -1
    s_mov_b32 exec_hi, 0
    s_mov_b32 s71, 0
    buffer_load_dword v2, v7, s[4:7], s47 offen sc1
    s_mov_b64 exec, -1
    s_waitcnt vmcnt(17)
    v_add_f32 v12, v12, v14
    v_add_f32 v16, v16, v18
    v_add_f32 v13, v13, v15
    v_add_f32 v17, v17, v19
    v_add_f32 v12, v12, v16
    v_add_f32 v13, v13, v17
    v_mov_b32 v14, v12
    v_mov_b32 v15, v13
    s_nop 0
    v_permlane16_swap_b32 v14, v12
    v_permlane16_swap_b32 v15, v13
    v_add_f32 v12, v12, v14
    v_add_f32 v13, v13, v15
    v_mov_b32 v14, v12
    v_mov_b32 v15, v13
    s_nop 0
    v_permlane32_swap_b32 v14, v12
    v_permlane32_swap_b32 v15, v13
    v_add_f32 v12, v12, v14
    v_add_f32 v13, v13, v15
    v_mul_f32 v12, 991054117, v12
    v_mul_f32 v13, 991054117, v13
    v_fma_f32 v13, -v12, v12, v13
    v_max_f32 v13, 0, v13
    v_cvt_pk_bf16_f32 v12, v12, v12
    v_lshlrev_b32 v12, 16, v12
    v_cvt_pk_bf16_f32 v14, v13, v13
    v_lshlrev_b32 v14, 16, v14
    v_add_f32 v14, 925353388, v14
    v_cvt_pk_bf16_f32 v14, v14, v14
    v_lshlrev_b32 v14, 16, v14
    v_sqrt_f32 v14, v14
    s_nop 0
    v_cvt_pk_bf16_f32 v14, v14, v14
    v_lshlrev_b32 v14, 16, v14
    v_and_b32 v6, 15, v1
    s_lshl_b32 s70, s51, 6
    s_add_u32 s70, s70, 161792
    v_lshl_add_u32 v6, v6, 2, s70
    ds_write2st64_b32 v6, v12, v14 offset0:0 offset1:1
    s_mov_b32 exec_lo, -1
    s_mov_b32 exec_hi, 0
    s_mov_b32 s71, 0
    s_waitcnt vmcnt(0)
    s_branch pollc_17
poll_15:
    buffer_load_dword v2, v7, s[4:7], s47 offen sc1
    s_add_u32 s71, s71, 1
    s_waitcnt vmcnt(0)
pollc_17:
    v_cmp_ne_u32 vcc, s50, v2
    s_nop 3
    s_cbranch_vccz polld_16
    s_cmp_lt_u32 s71, 400000
    s_cbranch_scc1 poll_15
polld_16:
    s_mov_b64 exec, -1
    v_mov_b32 v142, v44
    s_waitcnt lgkmcnt(0)
    v_mov_b32 v6, 163328
    v_mov_b32 v5, 1
    s_mov_b64 exec, 1
    ds_add_u32 v6, v5
    s_mov_b64 exec, -1
    s_waitcnt lgkmcnt(0)
    s_branch L_g3
L_side1:
    s_waitcnt lgkmcnt(0)
    s_waitcnt vmcnt(6)
    s_barrier
    s_mov_b32 m0, s18
    s_mov_b32 exec_hi, 0xFFFF
    global_load_lds_dwordx4 v[12:13], off
    s_mov_b32 exec_hi, -1
    s_mov_b32 s60, s38
    s_and_b32 s61, s39, 0xffff
    s_mov_b32 s62, 401408
    s_mov_b32 s63, 0x20000
    s_mul_i32 s70, s3, 14336
    s_mul_i32 s71, s94, 3584
    s_add_u32 s70, s70, s71
    v_lshlrev_b32 v5, 7, v1
    s_mov_b32 exec_hi, 0
    buffer_load_dword v140, v5, s[60:63], s70 offen
    s_mov_b32 exec_hi, -1
    s_mul_i32 s70, s3, 224
    s_mul_i32 s71, s94, 56
    s_add_u32 s70, s70, s71
    v_add_u32 v5, s70, v1
    v_and_b32 v6, -2, v5
    v_add_lshl_u32 v5, v5, v6, 7
    buffer_load_dword v141, v5, s[56:59], 0 offen
    s_setprio 3
    ds_read_b128 v[144:147], v18 offset:0
    ds_read_b128 v[148:151], v19 offset:0
    ds_read_b128 v[152:155], v18 offset:1024
    ds_read_b128 v[156:159], v19 offset:1024
    ds_read_b128 v[160:163], v18 offset:2048
    ds_read_b128 v[164:167], v19 offset:2048
    ds_read_b128 v[168:171], v18 offset:3072
    ds_read_b128 v[172:175], v19 offset:3072
    ds_read_b128 v[176:179], v18 offset:4096
    ds_read_b128 v[180:183], v19 offset:4096
    ds_read_b128 v[184:187], v18 offset:5120
    ds_read_b128 v[188:191], v19 offset:5120
    ds_read_b128 v[192:195], v18 offset:6144
    ds_read_b128 v[196:199], v19 offset:6144
    s_waitcnt lgkmcnt(13)
    v_mfma_f32_16x16x32_bf16 v[32:35], v[144:147], v[144:147], 0
    v_mfma_f32_16x16x32_bf16 v[36:39], v[28:31], v[144:147], 0
    s_waitcnt lgkmcnt(12)
    v_mfma_f32_16x16x32_bf16 v[32:35], v[148:151], v[148:151], v[32:35]
    v_mfma_f32_16x16x32_bf16 v[36:39], v[28:31], v[148:151], v[36:39]
    v_lshl_add_u32 v22, s40, 3, v20
    ds_read_b64_tr_b16 v[144:145], v22 offset:0
    ds_read_b64_tr_b16 v[146:147], v22 offset:512
    s_waitcnt lgkmcnt(13)
    v_mfma_f32_16x16x32_bf16 v[32:35], v[152:155], v[152:155], v[32:35]
    v_mfma_f32_16x16x32_bf16 v[36:39], v[28:31], v[152:155], v[36:39]
    ds_read_b64_tr_b16 v[148:149], v22 offset:4096
    ds_read_b64_tr_b16 v[150:151], v22 offset:4608
    s_waitcnt lgkmcnt(14)
    v_mfma_f32_16x16x32_bf16 v[32:35], v[156:159], v[156:159], v[32:35]
    v_mfma_f32_16x16x32_bf16 v[36:39], v[28:31], v[156:159], v[36:39]
    v_lshl_add_u32 v22, s41, 3, v20
    ds_read_b64_tr_b16 v[152:153], v22 offset:0
    ds_read_b64_tr_b16 v[154:155], v22 offset:512
    s_waitcnt lgkmcnt(15)
    v_mfma_f32_16x16x32_bf16 v[32:35], v[160:163], v[160:163], v[32:35]
    v_mfma_f32_16x16x32_bf16 v[36:39], v[28:31], v[160:163], v[36:39]
    ds_read_b64_tr_b16 v[156:157], v22 offset:4096
    ds_read_b64_tr_b16 v[158:159], v22 offset:4608
    s_waitcnt lgkmcnt(15)
    v_mfma_f32_16x16x32_bf16 v[32:35], v[164:167], v[164:167], v[32:35]
    v_mfma_f32_16x16x32_bf16 v[36:39], v[28:31], v[164:167], v[36:39]
    v_mfma_f32_16x16x32_bf16 v[32:35], v[168:171], v[168:171], v[32:35]
    v_mfma_f32_16x16x32_bf16 v[36:39], v[28:31], v[168:171], v[36:39]
    s_waitcnt lgkmcnt(14)
    v_mfma_f32_16x16x32_bf16 v[32:35], v[172:175], v[172:175], v[32:35]
    v_mfma_f32_16x16x32_bf16 v[36:39], v[28:31], v[172:175], v[36:39]
    s_waitcnt lgkmcnt(13)
    v_mfma_f32_16x16x32_bf16 v[32:35], v[176:179], v[176:179], v[32:35]
    v_mfma_f32_16x16x32_bf16 v[36:39], v[28:31], v[176:179], v[36:39]
    s_waitcnt lgkmcnt(12)
    v_mfma_f32_16x16x32_bf16 v[32:35], v[180:183], v[180:183], v[32:35]
    v_mfma_f32_16x16x32_bf16 v[36:39], v[28:31], v[180:183], v[36:39]
    s_waitcnt lgkmcnt(11)
    v_mfma_f32_16x16x32_bf16 v[32:35], v[184:187], v[184:187], v[32:35]
    v_mfma_f32_16x16x32_bf16 v[36:39], v[28:31], v[184:187], v[36:39]
    s_waitcnt lgkmcnt(10)
    v_mfma_f32_16x16x32_bf16 v[32:35], v[188:191], v[188:191], v[32:35]
    v_mfma_f32_16x16x32_bf16 v[36:39], v[28:31], v[188:191], v[36:39]
    s_waitcnt lgkmcnt(9)
    v_mfma_f32_16x16x32_bf16 v[32:35], v[192:195], v[192:195], v[32:35]
    v_mfma_f32_16x16x32_bf16 v[36:39], v[28:31], v[192:195], v[36:39]
    s_waitcnt lgkmcnt(8)
    v_mfma_f32_16x16x32_bf16 v[32:35], v[196:199], v[196:199], v[32:35]
    v_mfma_f32_16x16x32_bf16 v[36:39], v[28:31], v[196:199], v[36:39]
    s_waitcnt vmcnt(4)
    s_barrier
    s_waitcnt lgkmcnt(6)
    v_mfma_f32_16x16x32_bf16 v[40:43], v[144:147], v[24:27], 0
    s_waitcnt lgkmcnt(4)
    v_mfma_f32_16x16x32_bf16 v[40:43], v[148:151], v[24:27], v[40:43]
    s_waitcnt lgkmcnt(2)
    v_mfma_f32_16x16x32_bf16 v[40:43], v[152:155], v[24:27], v[40:43]
    s_waitcnt lgkmcnt(0)
    v_mfma_f32_16x16x32_bf16 v[40:43], v[156:159], v[24:27], v[40:43]
    v_lshl_add_u32 v22, s42, 3, v20
    ds_read_b64_tr_b16 v[160:161], v22 offset:0
    ds_read_b64_tr_b16 v[162:163], v22 offset:512
    ds_read_b64_tr_b16 v[164:165], v22 offset:4096
    ds_read_b64_tr_b16 v[166:167], v22 offset:4608
    v_lshl_add_u32 v22, s43, 3, v20
    ds_read_b64_tr_b16 v[168:169], v22 offset:0
    ds_read_b64_tr_b16 v[170:171], v22 offset:512
    ds_read_b64_tr_b16 v[172:173], v22 offset:4096
    ds_read_b64_tr_b16 v[174:175], v22 offset:4608
    v_lshl_add_u32 v22, s44, 3, v20
    ds_read_b64_tr_b16 v[176:177], v22 offset:0
    ds_read_b64_tr_b16 v[178:179], v22 offset:512
    ds_read_b64_tr_b16 v[180:181], v22 offset:4096
    ds_read_b64_tr_b16 v[182:183], v22 offset:4608
    v_lshl_add_u32 v22, s45, 3, v20
    ds_read_b64_tr_b16 v[184:185], v22 offset:0
    ds_read_b64_tr_b16 v[186:187], v22 offset:512
    s_mov_b32 s70, 0x22222222
    s_mov_b32 s71, 0x22222222
    v_cndmask_b32 v45, v32, v33, s[70:71]
    s_mov_b32 s70, 0x44444444
    s_mov_b32 s71, 0x44444444
    v_cndmask_b32 v45, v45, v34, s[70:71]
    s_mov_b32 s70, 0x88888888
    s_mov_b32 s71, 0x88888888
    v_cndmask_b32 v45, v45, v35, s[70:71]
    v_mul_f32 v44, 991054117, v36
    v_mul_f32 v45, 991054117, v45
    v_fma_f32 v45, -v44, v44, v45
    v_max_f32 v45, 0, v45
    v_cvt_pk_bf16_f32 v46, v44, v44
    v_lshlrev_b32 v46, 16, v46
    v_cvt_pk_bf16_f32 v47, v45, v45
    v_lshlrev_b32 v47, 16, v47
    v_add_f32 v47, 925353388, v47
    v_cvt_pk_bf16_f32 v47, v47, v47
    v_lshlrev_b32 v47, 16, v47
    v_sqrt_f32 v47, v47
    s_nop 0
    v_cvt_pk_bf16_f32 v47, v47, v47
    v_lshlrev_b32 v47, 16, v47
    v_rcp_f32 v48, v47
    v_sub_f32 v49, v44, v46
    v_mul_f32 v49, v49, v48
    v_mul_f32 v45, v45, v48
    v_mul_f32 v45, v45, v48
    v_cvt_pk_bf16_f32 v49, v49, v49
    v_lshlrev_b32 v49, 16, v49
    v_cvt_pk_bf16_f32 v50, v45, v45
    v_lshlrev_b32 v50, 16, v50
    v_add_f32 v50, 925353388, v50
    v_cvt_pk_bf16_f32 v50, v50, v50
    v_lshlrev_b32 v50, 16, v50
    v_sqrt_f32 v50, v50
    s_nop 0
    v_cvt_pk_bf16_f32 v50, v50, v50
    v_lshlrev_b32 v50, 16, v50
    v_rcp_f32 v50, v50
    v_fma_f32 v49, v47, v49, v46
    v_mul_f32 v46, -v46, v48
    v_mul_f32 v50, v50, v48
    v_and_b32 v5, 15, v1
    s_lshl_b32 s70, s94, 6
    s_add_u32 s70, s70, 161792
    v_lshl_add_u32 v5, v5, 2, s70
    s_mov_b32 exec_lo, 0x00F0000F
    s_mov_b32 exec_hi, 0xF0000F00
    ds_write2st64_b32 v5, v48, v46 offset0:0 offset1:1
    ds_write2st64_b32 v5, v49, v50 offset0:2 offset1:3
    s_mov_b64 exec, -1
    s_waitcnt vmcnt(3)
    v_readfirstlane_b32 s70, v4
    s_nop 0
    s_mul_i32 s50, s70, 0x9E3779B1
    s_add_u32 s50, s50, 0x7F4A7C15
    v_mov_b32 v4, s50
    v_mov_b32 v128, s50
    s_getreg_b32 s70, hwreg(HW_REG_XCC_ID)
    v_mov_b32 v129, s70
    v_mov_b32 v130, s50
    v_mov_b32 v131, s50
    v_mov_b32 v5, 163408
    ds_write_b32 v5, v4
    ds_read_b64_tr_b16 v[188:189], v22 offset:4096
    ds_read_b64_tr_b16 v[190:191], v22 offset:4608
    v_lshl_add_u32 v22, s46, 3, v20
    ds_read_b64_tr_b16 v[192:193], v22 offset:0
    ds_read_b64_tr_b16 v[194:195], v22 offset:512
    ds_read_b64_tr_b16 v[196:197], v22 offset:4096
    ds_read_b64_tr_b16 v[198:199], v22 offset:4608
    s_waitcnt lgkmcnt(15)
    v_mfma_f32_16x16x32_bf16 v[40:43], v[160:163], v[24:27], v[40:43]
    v_mfma_f32_16x16x32_bf16 v[40:43], v[164:167], v[24:27], v[40:43]
    v_mfma_f32_16x16x32_bf16 v[40:43], v[168:171], v[24:27], v[40:43]
    v_mfma_f32_16x16x32_bf16 v[40:43], v[172:175], v[24:27], v[40:43]
    s_waitcnt lgkmcnt(13)
    v_mfma_f32_16x16x32_bf16 v[40:43], v[176:179], v[24:27], v[40:43]
    s_waitcnt lgkmcnt(11)
    v_mfma_f32_16x16x32_bf16 v[40:43], v[180:183], v[24:27], v[40:43]
    s_waitcnt lgkmcnt(9)
    v_mfma_f32_16x16x32_bf16 v[40:43], v[184:187], v[24:27], v[40:43]
    s_waitcnt lgkmcnt(4)
    v_mfma_f32_16x16x32_bf16 v[40:43], v[188:191], v[24:27], v[40:43]
    s_waitcnt lgkmcnt(2)
    v_mfma_f32_16x16x32_bf16 v[40:43], v[192:195], v[24:27], v[40:43]
    s_waitcnt lgkmcnt(0)
    v_mfma_f32_16x16x32_bf16 v[40:43], v[196:199], v[24:27], v[40:43]
    s_setprio 0
    v_and_b32 v5, 1, v1
    v_lshlrev_b32 v5, 6, v5
    v_and_b32 v6, 48, v1
    s_lshl_b32 s70, s94, 7
    s_add_u32 s70, s70, 162816
    v_add3_u32 v6, v5, v6, s70
    s_mov_b32 exec_lo, 0x00030003
    s_mov_b32 exec_hi, 0x00030003
    ds_write_b128 v6, v[40:43]
    s_mov_b64 exec, -1
    s_waitcnt lgkmcnt(0)
    v_mov_b32 v6, 163396
    v_mov_b32 v5, 1
    s_mov_b64 exec, 1
    ds_add_u32 v6, v5
    s_mov_b64 exec, -1
    global_load_dwordx4 v[52:55], v21, s[96:97] offset:0
    global_load_dwordx2 v[56:57], v21, s[96:97] offset:16
    global_load_dwordx4 v[58:61], v21, s[96:97] offset:2048
    global_load_dwordx2 v[62:63], v21, s[96:97] offset:2064
    s_lshr_b32 s95, s94, 1
    s_and_b32 s93, s94, 1
    s_waitcnt vmcnt(6)
    s_setprio 1
    s_mul_i32 s47, s51, 4352
    s_add_u32 s47, s47, 114688
    s_mov_b32 m0, s47
    v_lshl_add_u32 v80, v1, 1, s18
    ds_read_u16_d16_hi v11, v80 offset:0
    ds_read_u16_d16_hi v12, v80 offset:128
    ds_read_u16_d16_hi v13, v80 offset:256
    ds_read_u16_d16_hi v14, v80 offset:384
    ds_read_u16_d16_hi v15, v80 offset:512
    ds_read_u16_d16_hi v16, v80 offset:640
    s_lshl_b32 s70, s34, 16
    s_and_b32 s71, s34, 0xffff0000
    s_bitcmp1_b32 s51, 0
    s_cselect_b32 s70, s71, s70
    v_mov_b32 v51, 1069066811
    v_mul_f32 v51, s70, v51
    v_exp_f32 v51, v51
    v_and_b32 v48, 15, v1
    v_mul_u32_u24 v48, 272, v48
    v_and_b32 v81, 48, v1
    v_add3_u32 v48, v48, v81, s47
    v_cvt_pk_bf16_f32 v51, v51, v51
    v_lshlrev_b32 v51, 16, v51
    s_waitcnt lgkmcnt(0)
    v_mul_f32 v49, v51, v11
    v_mul_f32 v50, v51, v12
    v_mul_f32 v49, 1069066811, v49
    v_mul_f32 v50, 1042479491, v50
    v_mul_f32 v46, v51, v13
    v_mul_f32 v47, v51, v14
    v_mov_b32 v44, v15
    v_mov_b32 v45, v16
    v_mul_f32 v216, 1090519040, v49
    v_mul_f32 v217, 1090519040, v50
    v_mul_f32 v218, 1065353216, v49
    v_mul_f32 v219, 1065353216, v50
    v_mul_f32 v220, 1124073472, v49
    v_mul_f32 v221, 1124073472, v50
    v_exp_f32 v216, v216
    v_fract_f32 v217, v217
    v_exp_f32 v218, v218
    v_fract_f32 v219, v219
    v_exp_f32 v220, v220
    v_fract_f32 v221, v221
    v_cos_f32 v246, v217
    v_sin_f32 v247, v217
    v_cos_f32 v244, v219
    v_sin_f32 v245, v219
    v_cos_f32 v248, v221
    v_sin_f32 v249, v221
    v_pk_mul_f32 v[18:19], v[44:45], v[46:47] op_sel_hi:[1,0]
    v_pk_fma_f32 v[28:29], v[44:45], v[46:47], v[18:19] op_sel:[1,1,0] op_sel_hi:[0,1,1] neg_lo:[1,0,0]
    v_mul_f32 v246, v216, v246
    v_mul_f32 v247, -v216, v247
    v_mul_f32 v244, v218, v244
    v_mul_f32 v245, v218, v245
    v_mul_f32 v248, v220, v248
    v_mul_f32 v249, v220, v249
    v_mov_b32 v80, 0x3f80
    v_cvt_pk_bf16_f32 v81, v246, v247
    v_pk_mul_f32 v[18:19], v[246:247], v[246:247] op_sel_hi:[1,0]
    v_pk_fma_f32 v[44:45], v[246:247], v[246:247], v[18:19] op_sel:[1,1,0] op_sel_hi:[0,1,1] neg_lo:[1,0,0]
    v_cvt_pk_bf16_f32 v82, v44, v45
    v_pk_mul_f32 v[18:19], v[44:45], v[246:247] op_sel_hi:[1,0]
    v_pk_fma_f32 v[44:45], v[44:45], v[246:247], v[18:19] op_sel:[1,1,0] op_sel_hi:[0,1,1] neg_lo:[1,0,0]
    v_cvt_pk_bf16_f32 v83, v44, v45
    v_pk_mul_f32 v[18:19], v[44:45], v[246:247] op_sel_hi:[1,0]
    v_pk_fma_f32 v[44:45], v[44:45], v[246:247], v[18:19] op_sel:[1,1,0] op_sel_hi:[0,1,1] neg_lo:[1,0,0]
    v_cvt_pk_bf16_f32 v84, v44, v45
    v_pk_mul_f32 v[18:19], v[44:45], v[246:247] op_sel_hi:[1,0]
    v_pk_fma_f32 v[44:45], v[44:45], v[246:247], v[18:19] op_sel:[1,1,0] op_sel_hi:[0,1,1] neg_lo:[1,0,0]
    v_cvt_pk_bf16_f32 v85, v44, v45
    v_pk_mul_f32 v[18:19], v[44:45], v[246:247] op_sel_hi:[1,0]
    v_pk_fma_f32 v[44:45], v[44:45], v[246:247], v[18:19] op_sel:[1,1,0] op_sel_hi:[0,1,1] neg_lo:[1,0,0]
    v_cvt_pk_bf16_f32 v86, v44, v45
    v_pk_mul_f32 v[18:19], v[44:45], v[246:247] op_sel_hi:[1,0]
    v_pk_fma_f32 v[44:45], v[44:45], v[246:247], v[18:19] op_sel:[1,1,0] op_sel_hi:[0,1,1] neg_lo:[1,0,0]
    v_cvt_pk_bf16_f32 v87, v44, v45
    ds_write_addtid_b32 v80 offset:0
    ds_write_addtid_b32 v81 offset:272
    ds_write_addtid_b32 v82 offset:544
    ds_write_addtid_b32 v83 offset:816
    ds_write_addtid_b32 v84 offset:1088
    ds_write_addtid_b32 v85 offset:1360
    ds_write_addtid_b32 v86 offset:1632
    ds_write_addtid_b32 v87 offset:1904
    v_pk_mul_f32 v[18:19], v[44:45], v[246:247] op_sel_hi:[1,0]
    v_pk_fma_f32 v[44:45], v[44:45], v[246:247], v[18:19] op_sel:[1,1,0] op_sel_hi:[0,1,1] neg_lo:[1,0,0]
    v_cvt_pk_bf16_f32 v80, v44, v45
    v_pk_mul_f32 v[18:19], v[44:45], v[246:247] op_sel_hi:[1,0]
    v_pk_fma_f32 v[44:45], v[44:45], v[246:247], v[18:19] op_sel:[1,1,0] op_sel_hi:[0,1,1] neg_lo:[1,0,0]
    v_cvt_pk_bf16_f32 v81, v44, v45
    v_pk_mul_f32 v[18:19], v[44:45], v[246:247] op_sel_hi:[1,0]
    v_pk_fma_f32 v[44:45], v[44:45], v[246:247], v[18:19] op_sel:[1,1,0] op_sel_hi:[0,1,1] neg_lo:[1,0,0]
    v_cvt_pk_bf16_f32 v82, v44, v45
    v_pk_mul_f32 v[18:19], v[44:45], v[246:247] op_sel_hi:[1,0]
    v_pk_fma_f32 v[44:45], v[44:45], v[246:247], v[18:19] op_sel:[1,1,0] op_sel_hi:[0,1,1] neg_lo:[1,0,0]
    v_cvt_pk_bf16_f32 v83, v44, v45
    v_pk_mul_f32 v[18:19], v[44:45], v[246:247] op_sel_hi:[1,0]
    v_pk_fma_f32 v[44:45], v[44:45], v[246:247], v[18:19] op_sel:[1,1,0] op_sel_hi:[0,1,1] neg_lo:[1,0,0]
    v_cvt_pk_bf16_f32 v84, v44, v45
    v_pk_mul_f32 v[18:19], v[44:45], v[246:247] op_sel_hi:[1,0]
    v_pk_fma_f32 v[44:45], v[44:45], v[246:247], v[18:19] op_sel:[1,1,0] op_sel_hi:[0,1,1] neg_lo:[1,0,0]
    v_cvt_pk_bf16_f32 v85, v44, v45
    v_pk_mul_f32 v[18:19], v[44:45], v[246:247] op_sel_hi:[1,0]
    v_pk_fma_f32 v[44:45], v[44:45], v[246:247], v[18:19] op_sel:[1,1,0] op_sel_hi:[0,1,1] neg_lo:[1,0,0]
    v_cvt_pk_bf16_f32 v86, v44, v45
    v_pk_mul_f32 v[18:19], v[44:45], v[246:247] op_sel_hi:[1,0]
    v_pk_fma_f32 v[44:45], v[44:45], v[246:247], v[18:19] op_sel:[1,1,0] op_sel_hi:[0,1,1] neg_lo:[1,0,0]
    v_cvt_pk_bf16_f32 v87, v44, v45
    ds_write_addtid_b32 v80 offset:2176
    ds_write_addtid_b32 v81 offset:2448
    ds_write_addtid_b32 v82 offset:2720
    ds_write_addtid_b32 v83 offset:2992
    ds_write_addtid_b32 v84 offset:3264
    ds_write_addtid_b32 v85 offset:3536
    ds_write_addtid_b32 v86 offset:3808
    ds_write_addtid_b32 v87 offset:4080
    ds_read_b128 v[200:203], v48 offset:0
    ds_read_b128 v[204:207], v48 offset:64
    ds_read_b128 v[208:211], v48 offset:128
    ds_read_b128 v[212:215], v48 offset:192
    v_pk_mul_f32 v[18:19], v[28:29], v[244:245] op_sel_hi:[1,0]
    v_pk_fma_f32 v[30:31], v[28:29], v[244:245], v[18:19] op_sel:[1,1,0] op_sel_hi:[0,1,1] neg_lo:[1,0,0]
    v_pk_mul_f32 v[18:19], v[30:31], v[244:245] op_sel_hi:[1,0]
    v_pk_fma_f32 v[32:33], v[30:31], v[244:245], v[18:19] op_sel:[1,1,0] op_sel_hi:[0,1,1] neg_lo:[1,0,0]
    v_pk_mul_f32 v[18:19], v[32:33], v[244:245] op_sel_hi:[1,0]
    v_pk_fma_f32 v[34:35], v[32:33], v[244:245], v[18:19] op_sel:[1,1,0] op_sel_hi:[0,1,1] neg_lo:[1,0,0]
    v_pk_mul_f32 v[18:19], v[34:35], v[244:245] op_sel_hi:[1,0]
    v_pk_fma_f32 v[36:37], v[34:35], v[244:245], v[18:19] op_sel:[1,1,0] op_sel_hi:[0,1,1] neg_lo:[1,0,0]
    v_pk_mul_f32 v[18:19], v[36:37], v[244:245] op_sel_hi:[1,0]
    v_pk_fma_f32 v[38:39], v[36:37], v[244:245], v[18:19] op_sel:[1,1,0] op_sel_hi:[0,1,1] neg_lo:[1,0,0]
    v_pk_mul_f32 v[18:19], v[38:39], v[244:245] op_sel_hi:[1,0]
    v_pk_fma_f32 v[40:41], v[38:39], v[244:245], v[18:19] op_sel:[1,1,0] op_sel_hi:[0,1,1] neg_lo:[1,0,0]
    v_pk_mul_f32 v[18:19], v[40:41], v[244:245] op_sel_hi:[1,0]
    v_pk_fma_f32 v[42:43], v[40:41], v[244:245], v[18:19] op_sel:[1,1,0] op_sel_hi:[0,1,1] neg_lo:[1,0,0]
    v_cvt_pk_bf16_f32 v80, v28, v29
    v_cvt_pk_bf16_f32 v81, v30, v31
    v_cvt_pk_bf16_f32 v82, v32, v33
    v_cvt_pk_bf16_f32 v83, v34, v35
    v_cvt_pk_bf16_f32 v84, v36, v37
    v_cvt_pk_bf16_f32 v85, v38, v39
    v_cvt_pk_bf16_f32 v86, v40, v41
    v_cvt_pk_bf16_f32 v87, v42, v43
    ds_write_addtid_b32 v80 offset:0
    ds_write_addtid_b32 v81 offset:272
    ds_write_addtid_b32 v82 offset:544
    ds_write_addtid_b32 v83 offset:816
    ds_write_addtid_b32 v84 offset:1088
    ds_write_addtid_b32 v85 offset:1360
    ds_write_addtid_b32 v86 offset:1632
    ds_write_addtid_b32 v87 offset:1904
    s_waitcnt lgkmcnt(0)
    v_mov_b32 v6, 163396
    s_mov_b32 s70, 0
ls_18:
    ds_read_b32 v5, v6
    s_add_u32 s70, s70, 1
    s_waitcnt lgkmcnt(0)
    v_readfirstlane_b32 s71, v5
    s_nop 0
    s_cmp_ge_u32 s71, 8
    s_nop 1
    s_cbranch_scc1 lsd_19
    s_cmp_lt_u32 s70, 3200000
    s_cbranch_scc1 ls_18
lsd_19:
    s_mov_b32 s12, s38
    s_and_b32 s13, s39, 0xffff
    s_mov_b32 s14, 401408
    s_mov_b32 s15, 0x20000
    s_mul_i32 s70, s51, 7
    s_mul_i32 s71, s70, 7168
    s_add_u32 s71, s71, s49
    s_lshl_b32 s70, s70, 10
    s_add_u32 m0, s70, 57344
    s_nop 0
    buffer_load_dwordx4 v8, s[12:15], s71 offen lds
    s_add_u32 s71, s71, 7168
    s_add_u32 m0, m0, 1024
    s_nop 0
    buffer_load_dwordx4 v8, s[12:15], s71 offen lds
    s_add_u32 s71, s71, 7168
    s_add_u32 m0, m0, 1024
    s_nop 0
    buffer_load_dwordx4 v8, s[12:15], s71 offen lds
    s_add_u32 s71, s71, 7168
    s_add_u32 m0, m0, 1024
    s_nop 0
    buffer_load_dwordx4 v8, s[12:15], s71 offen lds
    s_add_u32 s71, s71, 7168
    s_add_u32 m0, m0, 1024
    s_nop 0
    buffer_load_dwordx4 v8, s[12:15], s71 offen lds
    s_add_u32 s71, s71, 7168
    s_add_u32 m0, m0, 1024
    s_nop 0
    buffer_load_dwordx4 v8, s[12:15], s71 offen lds
    s_add_u32 s71, s71, 7168
    s_add_u32 m0, m0, 1024
    s_nop 0
    buffer_load_dwordx4 v8, s[12:15], s71 offen lds
    s_mov_b32 m0, s47
    v_pk_mul_f32 v[18:19], v[28:29], v[248:249] op_sel_hi:[1,0]
    v_pk_fma_f32 v[44:45], v[28:29], v[248:249], v[18:19] op_sel:[1,1,0] op_sel_hi:[0,1,1] neg_lo:[1,0,0]
    v_cvt_pk_bf16_f32 v80, v44, v45
    v_pk_mul_f32 v[18:19], v[30:31], v[248:249] op_sel_hi:[1,0]
    v_pk_fma_f32 v[44:45], v[30:31], v[248:249], v[18:19] op_sel:[1,1,0] op_sel_hi:[0,1,1] neg_lo:[1,0,0]
    v_cvt_pk_bf16_f32 v81, v44, v45
    v_pk_mul_f32 v[18:19], v[32:33], v[248:249] op_sel_hi:[1,0]
    v_pk_fma_f32 v[44:45], v[32:33], v[248:249], v[18:19] op_sel:[1,1,0] op_sel_hi:[0,1,1] neg_lo:[1,0,0]
    v_cvt_pk_bf16_f32 v82, v44, v45
    v_pk_mul_f32 v[18:19], v[34:35], v[248:249] op_sel_hi:[1,0]
    v_pk_fma_f32 v[44:45], v[34:35], v[248:249], v[18:19] op_sel:[1,1,0] op_sel_hi:[0,1,1] neg_lo:[1,0,0]
    v_cvt_pk_bf16_f32 v83, v44, v45
    v_pk_mul_f32 v[18:19], v[36:37], v[248:249] op_sel_hi:[1,0]
    v_pk_fma_f32 v[44:45], v[36:37], v[248:249], v[18:19] op_sel:[1,1,0] op_sel_hi:[0,1,1] neg_lo:[1,0,0]
    v_cvt_pk_bf16_f32 v84, v44, v45
    v_pk_mul_f32 v[18:19], v[38:39], v[248:249] op_sel_hi:[1,0]
    v_pk_fma_f32 v[44:45], v[38:39], v[248:249], v[18:19] op_sel:[1,1,0] op_sel_hi:[0,1,1] neg_lo:[1,0,0]
    v_cvt_pk_bf16_f32 v85, v44, v45
    v_pk_mul_f32 v[18:19], v[40:41], v[248:249] op_sel_hi:[1,0]
    v_pk_fma_f32 v[44:45], v[40:41], v[248:249], v[18:19] op_sel:[1,1,0] op_sel_hi:[0,1,1] neg_lo:[1,0,0]
    v_cvt_pk_bf16_f32 v86, v44, v45
    v_pk_mul_f32 v[18:19], v[42:43], v[248:249] op_sel_hi:[1,0]
    v_pk_fma_f32 v[44:45], v[42:43], v[248:249], v[18:19] op_sel:[1,1,0] op_sel_hi:[0,1,1] neg_lo:[1,0,0]
    v_cvt_pk_bf16_f32 v87, v44, v45
    ds_write_addtid_b32 v80 offset:2176
    ds_write_addtid_b32 v81 offset:2448
    ds_write_addtid_b32 v82 offset:2720
    ds_write_addtid_b32 v83 offset:2992
    ds_write_addtid_b32 v84 offset:3264
    ds_write_addtid_b32 v85 offset:3536
    ds_write_addtid_b32 v86 offset:3808
    ds_write_addtid_b32 v87 offset:4080
    ds_read_b128 v[216:219], v48 offset:0
    ds_read_b128 v[220:223], v48 offset:64
    ds_read_b128 v[224:227], v48 offset:128
    ds_read_b128 v[228:231], v48 offset:192
    v_pk_mul_f32 v[18:19], v[248:249], v[248:249] op_sel_hi:[1,0]
    v_pk_fma_f32 v[250:251], v[248:249], v[248:249], v[18:19] op_sel:[1,1,0] op_sel_hi:[0,1,1] neg_lo:[1,0,0]
    v_pk_mul_f32 v[18:19], v[250:251], v[250:251] op_sel_hi:[1,0]
    v_pk_fma_f32 v[252:253], v[250:251], v[250:251], v[18:19] op_sel:[1,1,0] op_sel_hi:[0,1,1] neg_lo:[1,0,0]
    v_pk_mul_f32 v[18:19], v[252:253], v[252:253] op_sel_hi:[1,0]
    v_pk_fma_f32 v[254:255], v[252:253], v[252:253], v[18:19] op_sel:[1,1,0] op_sel_hi:[0,1,1] neg_lo:[1,0,0]
    v_pk_mul_f32 v[18:19], v[28:29], v[250:251] op_sel_hi:[1,0]
    v_pk_fma_f32 v[30:31], v[28:29], v[250:251], v[18:19] op_sel:[1,1,0] op_sel_hi:[0,1,1] neg_lo:[1,0,0]
    v_cvt_pk_bf16_f32 v80, v30, v31
    v_pk_mul_f32 v[18:19], v[32:33], v[250:251] op_sel_hi:[1,0]
    v_pk_fma_f32 v[34:35], v[32:33], v[250:251], v[18:19] op_sel:[1,1,0] op_sel_hi:[0,1,1] neg_lo:[1,0,0]
    v_cvt_pk_bf16_f32 v81, v34, v35
    v_pk_mul_f32 v[18:19], v[36:37], v[250:251] op_sel_hi:[1,0]
    v_pk_fma_f32 v[38:39], v[36:37], v[250:251], v[18:19] op_sel:[1,1,0] op_sel_hi:[0,1,1] neg_lo:[1,0,0]
    v_cvt_pk_bf16_f32 v82, v38, v39
    v_pk_mul_f32 v[18:19], v[40:41], v[250:251] op_sel_hi:[1,0]
    v_pk_fma_f32 v[42:43], v[40:41], v[250:251], v[18:19] op_sel:[1,1,0] op_sel_hi:[0,1,1] neg_lo:[1,0,0]
    v_cvt_pk_bf16_f32 v83, v42, v43
    v_pk_mul_f32 v[18:19], v[30:31], v[248:249] op_sel_hi:[1,0]
    v_pk_fma_f32 v[30:31], v[30:31], v[248:249], v[18:19] op_sel:[1,1,0] op_sel_hi:[0,1,1] neg_lo:[1,0,0]
    v_cvt_pk_bf16_f32 v84, v30, v31
    v_pk_mul_f32 v[18:19], v[34:35], v[248:249] op_sel_hi:[1,0]
    v_pk_fma_f32 v[34:35], v[34:35], v[248:249], v[18:19] op_sel:[1,1,0] op_sel_hi:[0,1,1] neg_lo:[1,0,0]
    v_cvt_pk_bf16_f32 v85, v34, v35
    v_pk_mul_f32 v[18:19], v[38:39], v[248:249] op_sel_hi:[1,0]
    v_pk_fma_f32 v[38:39], v[38:39], v[248:249], v[18:19] op_sel:[1,1,0] op_sel_hi:[0,1,1] neg_lo:[1,0,0]
    v_cvt_pk_bf16_f32 v86, v38, v39
    v_pk_mul_f32 v[18:19], v[42:43], v[248:249] op_sel_hi:[1,0]
    v_pk_fma_f32 v[42:43], v[42:43], v[248:249], v[18:19] op_sel:[1,1,0] op_sel_hi:[0,1,1] neg_lo:[1,0,0]
    v_cvt_pk_bf16_f32 v87, v42, v43
    s_waitcnt lgkmcnt(0)
    v_mfma_f32_16x16x32_bf16 v[232:235], v[216:219], v[200:203], 0
    v_mfma_f32_16x16x32_bf16 v[232:235], v[220:223], v[204:207], v[232:235]
    v_mfma_f32_16x16x32_bf16 v[232:235], v[224:227], v[208:211], v[232:235]
    v_mfma_f32_16x16x32_bf16 v[232:235], v[228:231], v[212:215], v[232:235]
    ds_write_addtid_b32 v80 offset:0
    ds_write_addtid_b32 v81 offset:272
    ds_write_addtid_b32 v82 offset:544
    ds_write_addtid_b32 v83 offset:816
    ds_write_addtid_b32 v84 offset:1088
    ds_write_addtid_b32 v85 offset:1360
    ds_write_addtid_b32 v86 offset:1632
    ds_write_addtid_b32 v87 offset:1904
    v_pk_mul_f32 v[18:19], v[28:29], v[252:253] op_sel_hi:[1,0]
    v_pk_fma_f32 v[44:45], v[28:29], v[252:253], v[18:19] op_sel:[1,1,0] op_sel_hi:[0,1,1] neg_lo:[1,0,0]
    v_pk_mul_f32 v[18:19], v[36:37], v[252:253] op_sel_hi:[1,0]
    v_pk_fma_f32 v[46:47], v[36:37], v[252:253], v[18:19] op_sel:[1,1,0] op_sel_hi:[0,1,1] neg_lo:[1,0,0]
    v_cvt_pk_bf16_f32 v80, v44, v45
    v_cvt_pk_bf16_f32 v81, v46, v47
    v_pk_mul_f32 v[18:19], v[44:45], v[248:249] op_sel_hi:[1,0]
    v_pk_fma_f32 v[44:45], v[44:45], v[248:249], v[18:19] op_sel:[1,1,0] op_sel_hi:[0,1,1] neg_lo:[1,0,0]
    v_pk_mul_f32 v[18:19], v[46:47], v[248:249] op_sel_hi:[1,0]
    v_pk_fma_f32 v[46:47], v[46:47], v[248:249], v[18:19] op_sel:[1,1,0] op_sel_hi:[0,1,1] neg_lo:[1,0,0]
    v_cvt_pk_bf16_f32 v82, v44, v45
    v_cvt_pk_bf16_f32 v83, v46, v47
    v_pk_mul_f32 v[18:19], v[44:45], v[248:249] op_sel_hi:[1,0]
    v_pk_fma_f32 v[44:45], v[44:45], v[248:249], v[18:19] op_sel:[1,1,0] op_sel_hi:[0,1,1] neg_lo:[1,0,0]
    v_pk_mul_f32 v[18:19], v[46:47], v[248:249] op_sel_hi:[1,0]
    v_pk_fma_f32 v[46:47], v[46:47], v[248:249], v[18:19] op_sel:[1,1,0] op_sel_hi:[0,1,1] neg_lo:[1,0,0]
    v_cvt_pk_bf16_f32 v84, v44, v45
    v_cvt_pk_bf16_f32 v85, v46, v47
    v_pk_mul_f32 v[18:19], v[44:45], v[248:249] op_sel_hi:[1,0]
    v_pk_fma_f32 v[44:45], v[44:45], v[248:249], v[18:19] op_sel:[1,1,0] op_sel_hi:[0,1,1] neg_lo:[1,0,0]
    v_pk_mul_f32 v[18:19], v[46:47], v[248:249] op_sel_hi:[1,0]
    v_pk_fma_f32 v[46:47], v[46:47], v[248:249], v[18:19] op_sel:[1,1,0] op_sel_hi:[0,1,1] neg_lo:[1,0,0]
    v_cvt_pk_bf16_f32 v86, v44, v45
    v_cvt_pk_bf16_f32 v87, v46, v47
    ds_write_addtid_b32 v80 offset:2176
    ds_write_addtid_b32 v81 offset:2448
    ds_write_addtid_b32 v82 offset:2720
    ds_write_addtid_b32 v83 offset:2992
    ds_write_addtid_b32 v84 offset:3264
    ds_write_addtid_b32 v85 offset:3536
    ds_write_addtid_b32 v86 offset:3808
    ds_write_addtid_b32 v87 offset:4080
    ds_read_b128 v[64:67], v48 offset:0
    ds_read_b128 v[68:71], v48 offset:64
    ds_read_b128 v[72:75], v48 offset:128
    ds_read_b128 v[76:79], v48 offset:192
    v_pk_mul_f32 v[18:19], v[28:29], v[254:255] op_sel_hi:[1,0]
    v_pk_fma_f32 v[44:45], v[28:29], v[254:255], v[18:19] op_sel:[1,1,0] op_sel_hi:[0,1,1] neg_lo:[1,0,0]
    v_cvt_pk_bf16_f32 v80, v44, v45
    v_pk_mul_f32 v[18:19], v[44:45], v[248:249] op_sel_hi:[1,0]
    v_pk_fma_f32 v[44:45], v[44:45], v[248:249], v[18:19] op_sel:[1,1,0] op_sel_hi:[0,1,1] neg_lo:[1,0,0]
    v_cvt_pk_bf16_f32 v81, v44, v45
    v_pk_mul_f32 v[18:19], v[44:45], v[248:249] op_sel_hi:[1,0]
    v_pk_fma_f32 v[44:45], v[44:45], v[248:249], v[18:19] op_sel:[1,1,0] op_sel_hi:[0,1,1] neg_lo:[1,0,0]
    v_cvt_pk_bf16_f32 v82, v44, v45
    v_pk_mul_f32 v[18:19], v[44:45], v[248:249] op_sel_hi:[1,0]
    v_pk_fma_f32 v[44:45], v[44:45], v[248:249], v[18:19] op_sel:[1,1,0] op_sel_hi:[0,1,1] neg_lo:[1,0,0]
    v_cvt_pk_bf16_f32 v83, v44, v45
    v_pk_mul_f32 v[18:19], v[44:45], v[248:249] op_sel_hi:[1,0]
    v_pk_fma_f32 v[44:45], v[44:45], v[248:249], v[18:19] op_sel:[1,1,0] op_sel_hi:[0,1,1] neg_lo:[1,0,0]
    v_cvt_pk_bf16_f32 v84, v44, v45
    v_pk_mul_f32 v[18:19], v[44:45], v[248:249] op_sel_hi:[1,0]
    v_pk_fma_f32 v[44:45], v[44:45], v[248:249], v[18:19] op_sel:[1,1,0] op_sel_hi:[0,1,1] neg_lo:[1,0,0]
    v_cvt_pk_bf16_f32 v85, v44, v45
    v_pk_mul_f32 v[18:19], v[44:45], v[248:249] op_sel_hi:[1,0]
    v_pk_fma_f32 v[44:45], v[44:45], v[248:249], v[18:19] op_sel:[1,1,0] op_sel_hi:[0,1,1] neg_lo:[1,0,0]
    v_cvt_pk_bf16_f32 v86, v44, v45
    v_pk_mul_f32 v[18:19], v[44:45], v[248:249] op_sel_hi:[1,0]
    v_pk_fma_f32 v[44:45], v[44:45], v[248:249], v[18:19] op_sel:[1,1,0] op_sel_hi:[0,1,1] neg_lo:[1,0,0]
    v_cvt_pk_bf16_f32 v87, v44, v45
    v_pk_mul_f32 v[18:19], v[44:45], v[248:249] op_sel_hi:[1,0]
    v_pk_fma_f32 v[44:45], v[44:45], v[248:249], v[18:19] op_sel:[1,1,0] op_sel_hi:[0,1,1] neg_lo:[1,0,0]
    s_waitcnt lgkmcnt(0)
    v_mfma_f32_16x16x32_bf16 v[236:239], v[64:67], v[200:203], 0
    v_mfma_f32_16x16x32_bf16 v[236:239], v[68:71], v[204:207], v[236:239]
    v_mfma_f32_16x16x32_bf16 v[236:239], v[72:75], v[208:211], v[236:239]
    v_mfma_f32_16x16x32_bf16 v[236:239], v[76:79], v[212:215], v[236:239]
    ds_write_addtid_b32 v80 offset:0
    ds_write_addtid_b32 v81 offset:272
    ds_write_addtid_b32 v82 offset:544
    ds_write_addtid_b32 v83 offset:816
    ds_write_addtid_b32 v84 offset:1088
    ds_write_addtid_b32 v85 offset:1360
    ds_write_addtid_b32 v86 offset:1632
    ds_write_addtid_b32 v87 offset:1904
    v_cvt_pk_bf16_f32 v80, v44, v45
    ds_write_addtid_b32 v80 offset:2176
    ds_read_b128 v[216:219], v48 offset:0
    ds_read_b128 v[220:223], v48 offset:64
    ds_read_b128 v[224:227], v48 offset:128
    ds_read_b128 v[228:231], v48 offset:192
    s_waitcnt vmcnt(0)
    v_mov_b32 v6, 163332
    v_mov_b32 v5, 1
    s_mov_b64 exec, 1
    ds_add_u32 v6, v5
    s_mov_b64 exec, -1
    s_mov_b32 m0, s47
    s_waitcnt lgkmcnt(1)
    v_mfma_f32_16x16x32_bf16 v[240:243], v[216:219], v[200:203], 0
    v_mfma_f32_16x16x32_bf16 v[240:243], v[220:223], v[204:207], v[240:243]
    v_mfma_f32_16x16x32_bf16 v[240:243], v[224:227], v[208:211], v[240:243]
    v_mfma_f32_16x16x32_bf16 v[240:243], v[228:231], v[212:215], v[240:243]
    s_sub_u32 s18, s18, 4096
    s_mul_i32 s47, s51, 4352
    s_add_u32 s47, s47, 114688
    s_mov_b32 m0, s47
    v_lshl_add_u32 v80, v1, 1, s18
    ds_read_u16_d16_hi v11, v80 offset:0
    ds_read_u16_d16_hi v12, v80 offset:128
    ds_read_u16_d16_hi v13, v80 offset:256
    ds_read_u16_d16_hi v14, v80 offset:384
    ds_read_u16_d16_hi v15, v80 offset:512
    ds_read_u16_d16_hi v16, v80 offset:640
    s_lshl_b32 s70, s34, 16
    s_and_b32 s71, s34, 0xffff0000
    s_bitcmp1_b32 s51, 0
    s_cselect_b32 s70, s71, s70
    v_mov_b32 v51, 1069066811
    v_mul_f32 v51, s70, v51
    v_exp_f32 v51, v51
    v_and_b32 v48, 15, v1
    v_mul_u32_u24 v48, 272, v48
    v_and_b32 v81, 48, v1
    v_add3_u32 v48, v48, v81, s47
    v_cvt_pk_bf16_f32 v51, v51, v51
    v_lshlrev_b32 v51, 16, v51
    s_waitcnt lgkmcnt(0)
    v_mul_f32 v49, v51, v11
    v_mul_f32 v50, v51, v12
    v_mul_f32 v49, 1069066811, v49
    v_mul_f32 v50, 1042479491, v50
    v_mul_f32 v46, v51, v13
    v_mul_f32 v47, v51, v14
    v_mov_b32 v44, v15
    v_mov_b32 v45, v16
    v_mul_f32 v216, 1090519040, v49
    v_mul_f32 v217, 1090519040, v50
    v_mul_f32 v218, 1065353216, v49
    v_mul_f32 v219, 1065353216, v50
    v_mul_f32 v220, 1124073472, v49
    v_mul_f32 v221, 1124073472, v50
    v_exp_f32 v216, v216
    v_fract_f32 v217, v217
    v_exp_f32 v218, v218
    v_fract_f32 v219, v219
    v_exp_f32 v220, v220
    v_fract_f32 v221, v221
    v_cos_f32 v246, v217
    v_sin_f32 v247, v217
    v_cos_f32 v244, v219
    v_sin_f32 v245, v219
    v_cos_f32 v248, v221
    v_sin_f32 v249, v221
    v_pk_mul_f32 v[18:19], v[44:45], v[46:47] op_sel_hi:[1,0]
    v_pk_fma_f32 v[28:29], v[44:45], v[46:47], v[18:19] op_sel:[1,1,0] op_sel_hi:[0,1,1] neg_lo:[1,0,0]
    v_mul_f32 v246, v216, v246
    v_mul_f32 v247, -v216, v247
    v_mul_f32 v244, v218, v244
    v_mul_f32 v245, v218, v245
    v_mul_f32 v248, v220, v248
    v_mul_f32 v249, v220, v249
    v_mov_b32 v80, 0x3f80
    v_cvt_pk_bf16_f32 v81, v246, v247
    v_pk_mul_f32 v[18:19], v[246:247], v[246:247] op_sel_hi:[1,0]
    v_pk_fma_f32 v[44:45], v[246:247], v[246:247], v[18:19] op_sel:[1,1,0] op_sel_hi:[0,1,1] neg_lo:[1,0,0]
    v_cvt_pk_bf16_f32 v82, v44, v45
    v_pk_mul_f32 v[18:19], v[44:45], v[246:247] op_sel_hi:[1,0]
    v_pk_fma_f32 v[44:45], v[44:45], v[246:247], v[18:19] op_sel:[1,1,0] op_sel_hi:[0,1,1] neg_lo:[1,0,0]
    v_cvt_pk_bf16_f32 v83, v44, v45
    v_pk_mul_f32 v[18:19], v[44:45], v[246:247] op_sel_hi:[1,0]
    v_pk_fma_f32 v[44:45], v[44:45], v[246:247], v[18:19] op_sel:[1,1,0] op_sel_hi:[0,1,1] neg_lo:[1,0,0]
    v_cvt_pk_bf16_f32 v84, v44, v45
    v_pk_mul_f32 v[18:19], v[44:45], v[246:247] op_sel_hi:[1,0]
    v_pk_fma_f32 v[44:45], v[44:45], v[246:247], v[18:19] op_sel:[1,1,0] op_sel_hi:[0,1,1] neg_lo:[1,0,0]
    v_cvt_pk_bf16_f32 v85, v44, v45
    v_pk_mul_f32 v[18:19], v[44:45], v[246:247] op_sel_hi:[1,0]
    v_pk_fma_f32 v[44:45], v[44:45], v[246:247], v[18:19] op_sel:[1,1,0] op_sel_hi:[0,1,1] neg_lo:[1,0,0]
    v_cvt_pk_bf16_f32 v86, v44, v45
    v_pk_mul_f32 v[18:19], v[44:45], v[246:247] op_sel_hi:[1,0]
    v_pk_fma_f32 v[44:45], v[44:45], v[246:247], v[18:19] op_sel:[1,1,0] op_sel_hi:[0,1,1] neg_lo:[1,0,0]
    v_cvt_pk_bf16_f32 v87, v44, v45
    ds_write_addtid_b32 v80 offset:0
    ds_write_addtid_b32 v81 offset:272
    ds_write_addtid_b32 v82 offset:544
    ds_write_addtid_b32 v83 offset:816
    ds_write_addtid_b32 v84 offset:1088
    ds_write_addtid_b32 v85 offset:1360
    ds_write_addtid_b32 v86 offset:1632
    ds_write_addtid_b32 v87 offset:1904
    v_pk_mul_f32 v[18:19], v[44:45], v[246:247] op_sel_hi:[1,0]
    v_pk_fma_f32 v[44:45], v[44:45], v[246:247], v[18:19] op_sel:[1,1,0] op_sel_hi:[0,1,1] neg_lo:[1,0,0]
    v_cvt_pk_bf16_f32 v80, v44, v45
    v_pk_mul_f32 v[18:19], v[44:45], v[246:247] op_sel_hi:[1,0]
    v_pk_fma_f32 v[44:45], v[44:45], v[246:247], v[18:19] op_sel:[1,1,0] op_sel_hi:[0,1,1] neg_lo:[1,0,0]
    v_cvt_pk_bf16_f32 v81, v44, v45
    v_pk_mul_f32 v[18:19], v[44:45], v[246:247] op_sel_hi:[1,0]
    v_pk_fma_f32 v[44:45], v[44:45], v[246:247], v[18:19] op_sel:[1,1,0] op_sel_hi:[0,1,1] neg_lo:[1,0,0]
    v_cvt_pk_bf16_f32 v82, v44, v45
    v_pk_mul_f32 v[18:19], v[44:45], v[246:247] op_sel_hi:[1,0]
    v_pk_fma_f32 v[44:45], v[44:45], v[246:247], v[18:19] op_sel:[1,1,0] op_sel_hi:[0,1,1] neg_lo:[1,0,0]
    v_cvt_pk_bf16_f32 v83, v44, v45
    v_pk_mul_f32 v[18:19], v[44:45], v[246:247] op_sel_hi:[1,0]
    v_pk_fma_f32 v[44:45], v[44:45], v[246:247], v[18:19] op_sel:[1,1,0] op_sel_hi:[0,1,1] neg_lo:[1,0,0]
    v_cvt_pk_bf16_f32 v84, v44, v45
    v_pk_mul_f32 v[18:19], v[44:45], v[246:247] op_sel_hi:[1,0]
    v_pk_fma_f32 v[44:45], v[44:45], v[246:247], v[18:19] op_sel:[1,1,0] op_sel_hi:[0,1,1] neg_lo:[1,0,0]
    v_cvt_pk_bf16_f32 v85, v44, v45
    v_pk_mul_f32 v[18:19], v[44:45], v[246:247] op_sel_hi:[1,0]
    v_pk_fma_f32 v[44:45], v[44:45], v[246:247], v[18:19] op_sel:[1,1,0] op_sel_hi:[0,1,1] neg_lo:[1,0,0]
    v_cvt_pk_bf16_f32 v86, v44, v45
    v_pk_mul_f32 v[18:19], v[44:45], v[246:247] op_sel_hi:[1,0]
    v_pk_fma_f32 v[44:45], v[44:45], v[246:247], v[18:19] op_sel:[1,1,0] op_sel_hi:[0,1,1] neg_lo:[1,0,0]
    v_cvt_pk_bf16_f32 v87, v44, v45
    ds_write_addtid_b32 v80 offset:2176
    ds_write_addtid_b32 v81 offset:2448
    ds_write_addtid_b32 v82 offset:2720
    ds_write_addtid_b32 v83 offset:2992
    ds_write_addtid_b32 v84 offset:3264
    ds_write_addtid_b32 v85 offset:3536
    ds_write_addtid_b32 v86 offset:3808
    ds_write_addtid_b32 v87 offset:4080
    ds_read_b128 v[200:203], v48 offset:0
    ds_read_b128 v[204:207], v48 offset:64
    ds_read_b128 v[208:211], v48 offset:128
    ds_read_b128 v[212:215], v48 offset:192
    v_pk_mul_f32 v[18:19], v[28:29], v[244:245] op_sel_hi:[1,0]
    v_pk_fma_f32 v[30:31], v[28:29], v[244:245], v[18:19] op_sel:[1,1,0] op_sel_hi:[0,1,1] neg_lo:[1,0,0]
    v_pk_mul_f32 v[18:19], v[30:31], v[244:245] op_sel_hi:[1,0]
    v_pk_fma_f32 v[32:33], v[30:31], v[244:245], v[18:19] op_sel:[1,1,0] op_sel_hi:[0,1,1] neg_lo:[1,0,0]
    v_pk_mul_f32 v[18:19], v[32:33], v[244:245] op_sel_hi:[1,0]
    v_pk_fma_f32 v[34:35], v[32:33], v[244:245], v[18:19] op_sel:[1,1,0] op_sel_hi:[0,1,1] neg_lo:[1,0,0]
    v_pk_mul_f32 v[18:19], v[34:35], v[244:245] op_sel_hi:[1,0]
    v_pk_fma_f32 v[36:37], v[34:35], v[244:245], v[18:19] op_sel:[1,1,0] op_sel_hi:[0,1,1] neg_lo:[1,0,0]
    v_pk_mul_f32 v[18:19], v[36:37], v[244:245] op_sel_hi:[1,0]
    v_pk_fma_f32 v[38:39], v[36:37], v[244:245], v[18:19] op_sel:[1,1,0] op_sel_hi:[0,1,1] neg_lo:[1,0,0]
    v_pk_mul_f32 v[18:19], v[38:39], v[244:245] op_sel_hi:[1,0]
    v_pk_fma_f32 v[40:41], v[38:39], v[244:245], v[18:19] op_sel:[1,1,0] op_sel_hi:[0,1,1] neg_lo:[1,0,0]
    v_pk_mul_f32 v[18:19], v[40:41], v[244:245] op_sel_hi:[1,0]
    v_pk_fma_f32 v[42:43], v[40:41], v[244:245], v[18:19] op_sel:[1,1,0] op_sel_hi:[0,1,1] neg_lo:[1,0,0]
    v_cvt_pk_bf16_f32 v80, v28, v29
    v_cvt_pk_bf16_f32 v81, v30, v31
    v_cvt_pk_bf16_f32 v82, v32, v33
    v_cvt_pk_bf16_f32 v83, v34, v35
    v_cvt_pk_bf16_f32 v84, v36, v37
    v_cvt_pk_bf16_f32 v85, v38, v39
    v_cvt_pk_bf16_f32 v86, v40, v41
    v_cvt_pk_bf16_f32 v87, v42, v43
    ds_write_addtid_b32 v80 offset:0
    ds_write_addtid_b32 v81 offset:272
    ds_write_addtid_b32 v82 offset:544
    ds_write_addtid_b32 v83 offset:816
    ds_write_addtid_b32 v84 offset:1088
    ds_write_addtid_b32 v85 offset:1360
    ds_write_addtid_b32 v86 offset:1632
    ds_write_addtid_b32 v87 offset:1904
    v_pk_mul_f32 v[18:19], v[28:29], v[248:249] op_sel_hi:[1,0]
    v_pk_fma_f32 v[44:45], v[28:29], v[248:249], v[18:19] op_sel:[1,1,0] op_sel_hi:[0,1,1] neg_lo:[1,0,0]
    v_cvt_pk_bf16_f32 v80, v44, v45
    v_pk_mul_f32 v[18:19], v[30:31], v[248:249] op_sel_hi:[1,0]
    v_pk_fma_f32 v[44:45], v[30:31], v[248:249], v[18:19] op_sel:[1,1,0] op_sel_hi:[0,1,1] neg_lo:[1,0,0]
    v_cvt_pk_bf16_f32 v81, v44, v45
    v_pk_mul_f32 v[18:19], v[32:33], v[248:249] op_sel_hi:[1,0]
    v_pk_fma_f32 v[44:45], v[32:33], v[248:249], v[18:19] op_sel:[1,1,0] op_sel_hi:[0,1,1] neg_lo:[1,0,0]
    v_cvt_pk_bf16_f32 v82, v44, v45
    v_pk_mul_f32 v[18:19], v[34:35], v[248:249] op_sel_hi:[1,0]
    v_pk_fma_f32 v[44:45], v[34:35], v[248:249], v[18:19] op_sel:[1,1,0] op_sel_hi:[0,1,1] neg_lo:[1,0,0]
    v_cvt_pk_bf16_f32 v83, v44, v45
    v_pk_mul_f32 v[18:19], v[36:37], v[248:249] op_sel_hi:[1,0]
    v_pk_fma_f32 v[44:45], v[36:37], v[248:249], v[18:19] op_sel:[1,1,0] op_sel_hi:[0,1,1] neg_lo:[1,0,0]
    v_cvt_pk_bf16_f32 v84, v44, v45
    v_pk_mul_f32 v[18:19], v[38:39], v[248:249] op_sel_hi:[1,0]
    v_pk_fma_f32 v[44:45], v[38:39], v[248:249], v[18:19] op_sel:[1,1,0] op_sel_hi:[0,1,1] neg_lo:[1,0,0]
    v_cvt_pk_bf16_f32 v85, v44, v45
    v_pk_mul_f32 v[18:19], v[40:41], v[248:249] op_sel_hi:[1,0]
    v_pk_fma_f32 v[44:45], v[40:41], v[248:249], v[18:19] op_sel:[1,1,0] op_sel_hi:[0,1,1] neg_lo:[1,0,0]
    v_cvt_pk_bf16_f32 v86, v44, v45
    v_pk_mul_f32 v[18:19], v[42:43], v[248:249] op_sel_hi:[1,0]
    v_pk_fma_f32 v[44:45], v[42:43], v[248:249], v[18:19] op_sel:[1,1,0] op_sel_hi:[0,1,1] neg_lo:[1,0,0]
    v_cvt_pk_bf16_f32 v87, v44, v45
    ds_write_addtid_b32 v80 offset:2176
    ds_write_addtid_b32 v81 offset:2448
    ds_write_addtid_b32 v82 offset:2720
    ds_write_addtid_b32 v83 offset:2992
    ds_write_addtid_b32 v84 offset:3264
    ds_write_addtid_b32 v85 offset:3536
    ds_write_addtid_b32 v86 offset:3808
    ds_write_addtid_b32 v87 offset:4080
    ds_read_b128 v[216:219], v48 offset:0
    ds_read_b128 v[220:223], v48 offset:64
    ds_read_b128 v[224:227], v48 offset:128
    ds_read_b128 v[228:231], v48 offset:192
    v_pk_mul_f32 v[18:19], v[248:249], v[248:249] op_sel_hi:[1,0]
    v_pk_fma_f32 v[250:251], v[248:249], v[248:249], v[18:19] op_sel:[1,1,0] op_sel_hi:[0,1,1] neg_lo:[1,0,0]
    v_pk_mul_f32 v[18:19], v[250:251], v[250:251] op_sel_hi:[1,0]
    v_pk_fma_f32 v[252:253], v[250:251], v[250:251], v[18:19] op_sel:[1,1,0] op_sel_hi:[0,1,1] neg_lo:[1,0,0]
    v_pk_mul_f32 v[18:19], v[252:253], v[252:253] op_sel_hi:[1,0]
    v_pk_fma_f32 v[254:255], v[252:253], v[252:253], v[18:19] op_sel:[1,1,0] op_sel_hi:[0,1,1] neg_lo:[1,0,0]
    v_pk_mul_f32 v[18:19], v[28:29], v[250:251] op_sel_hi:[1,0]
    v_pk_fma_f32 v[30:31], v[28:29], v[250:251], v[18:19] op_sel:[1,1,0] op_sel_hi:[0,1,1] neg_lo:[1,0,0]
    v_cvt_pk_bf16_f32 v80, v30, v31
    v_pk_mul_f32 v[18:19], v[32:33], v[250:251] op_sel_hi:[1,0]
    v_pk_fma_f32 v[34:35], v[32:33], v[250:251], v[18:19] op_sel:[1,1,0] op_sel_hi:[0,1,1] neg_lo:[1,0,0]
    v_cvt_pk_bf16_f32 v81, v34, v35
    v_pk_mul_f32 v[18:19], v[36:37], v[250:251] op_sel_hi:[1,0]
    v_pk_fma_f32 v[38:39], v[36:37], v[250:251], v[18:19] op_sel:[1,1,0] op_sel_hi:[0,1,1] neg_lo:[1,0,0]
    v_cvt_pk_bf16_f32 v82, v38, v39
    v_pk_mul_f32 v[18:19], v[40:41], v[250:251] op_sel_hi:[1,0]
    v_pk_fma_f32 v[42:43], v[40:41], v[250:251], v[18:19] op_sel:[1,1,0] op_sel_hi:[0,1,1] neg_lo:[1,0,0]
    v_cvt_pk_bf16_f32 v83, v42, v43
    v_pk_mul_f32 v[18:19], v[30:31], v[248:249] op_sel_hi:[1,0]
    v_pk_fma_f32 v[30:31], v[30:31], v[248:249], v[18:19] op_sel:[1,1,0] op_sel_hi:[0,1,1] neg_lo:[1,0,0]
    v_cvt_pk_bf16_f32 v84, v30, v31
    v_pk_mul_f32 v[18:19], v[34:35], v[248:249] op_sel_hi:[1,0]
    v_pk_fma_f32 v[34:35], v[34:35], v[248:249], v[18:19] op_sel:[1,1,0] op_sel_hi:[0,1,1] neg_lo:[1,0,0]
    v_cvt_pk_bf16_f32 v85, v34, v35
    v_pk_mul_f32 v[18:19], v[38:39], v[248:249] op_sel_hi:[1,0]
    v_pk_fma_f32 v[38:39], v[38:39], v[248:249], v[18:19] op_sel:[1,1,0] op_sel_hi:[0,1,1] neg_lo:[1,0,0]
    v_cvt_pk_bf16_f32 v86, v38, v39
    v_pk_mul_f32 v[18:19], v[42:43], v[248:249] op_sel_hi:[1,0]
    v_pk_fma_f32 v[42:43], v[42:43], v[248:249], v[18:19] op_sel:[1,1,0] op_sel_hi:[0,1,1] neg_lo:[1,0,0]
    v_cvt_pk_bf16_f32 v87, v42, v43
    s_waitcnt lgkmcnt(0)
    v_mfma_f32_16x16x32_bf16 v[232:235], v[216:219], v[200:203], v[232:235]
    v_mfma_f32_16x16x32_bf16 v[232:235], v[220:223], v[204:207], v[232:235]
    v_mfma_f32_16x16x32_bf16 v[232:235], v[224:227], v[208:211], v[232:235]
    v_mfma_f32_16x16x32_bf16 v[232:235], v[228:231], v[212:215], v[232:235]
    ds_write_addtid_b32 v80 offset:0
    ds_write_addtid_b32 v81 offset:272
    ds_write_addtid_b32 v82 offset:544
    ds_write_addtid_b32 v83 offset:816
    ds_write_addtid_b32 v84 offset:1088
    ds_write_addtid_b32 v85 offset:1360
    ds_write_addtid_b32 v86 offset:1632
    ds_write_addtid_b32 v87 offset:1904
    v_pk_mul_f32 v[18:19], v[28:29], v[252:253] op_sel_hi:[1,0]
    v_pk_fma_f32 v[44:45], v[28:29], v[252:253], v[18:19] op_sel:[1,1,0] op_sel_hi:[0,1,1] neg_lo:[1,0,0]
    v_pk_mul_f32 v[18:19], v[36:37], v[252:253] op_sel_hi:[1,0]
    v_pk_fma_f32 v[46:47], v[36:37], v[252:253], v[18:19] op_sel:[1,1,0] op_sel_hi:[0,1,1] neg_lo:[1,0,0]
    v_cvt_pk_bf16_f32 v80, v44, v45
    v_cvt_pk_bf16_f32 v81, v46, v47
    v_pk_mul_f32 v[18:19], v[44:45], v[248:249] op_sel_hi:[1,0]
    v_pk_fma_f32 v[44:45], v[44:45], v[248:249], v[18:19] op_sel:[1,1,0] op_sel_hi:[0,1,1] neg_lo:[1,0,0]
    v_pk_mul_f32 v[18:19], v[46:47], v[248:249] op_sel_hi:[1,0]
    v_pk_fma_f32 v[46:47], v[46:47], v[248:249], v[18:19] op_sel:[1,1,0] op_sel_hi:[0,1,1] neg_lo:[1,0,0]
    v_cvt_pk_bf16_f32 v82, v44, v45
    v_cvt_pk_bf16_f32 v83, v46, v47
    v_pk_mul_f32 v[18:19], v[44:45], v[248:249] op_sel_hi:[1,0]
    v_pk_fma_f32 v[44:45], v[44:45], v[248:249], v[18:19] op_sel:[1,1,0] op_sel_hi:[0,1,1] neg_lo:[1,0,0]
    v_pk_mul_f32 v[18:19], v[46:47], v[248:249] op_sel_hi:[1,0]
    v_pk_fma_f32 v[46:47], v[46:47], v[248:249], v[18:19] op_sel:[1,1,0] op_sel_hi:[0,1,1] neg_lo:[1,0,0]
    v_cvt_pk_bf16_f32 v84, v44, v45
    v_cvt_pk_bf16_f32 v85, v46, v47
    v_pk_mul_f32 v[18:19], v[44:45], v[248:249] op_sel_hi:[1,0]
    v_pk_fma_f32 v[44:45], v[44:45], v[248:249], v[18:19] op_sel:[1,1,0] op_sel_hi:[0,1,1] neg_lo:[1,0,0]
    v_pk_mul_f32 v[18:19], v[46:47], v[248:249] op_sel_hi:[1,0]
    v_pk_fma_f32 v[46:47], v[46:47], v[248:249], v[18:19] op_sel:[1,1,0] op_sel_hi:[0,1,1] neg_lo:[1,0,0]
    v_cvt_pk_bf16_f32 v86, v44, v45
    v_cvt_pk_bf16_f32 v87, v46, v47
    ds_write_addtid_b32 v80 offset:2176
    ds_write_addtid_b32 v81 offset:2448
    ds_write_addtid_b32 v82 offset:2720
    ds_write_addtid_b32 v83 offset:2992
    ds_write_addtid_b32 v84 offset:3264
    ds_write_addtid_b32 v85 offset:3536
    ds_write_addtid_b32 v86 offset:3808
    ds_write_addtid_b32 v87 offset:4080
    ds_read_b128 v[64:67], v48 offset:0
    ds_read_b128 v[68:71], v48 offset:64
    ds_read_b128 v[72:75], v48 offset:128
    ds_read_b128 v[76:79], v48 offset:192
    v_pk_mul_f32 v[18:19], v[28:29], v[254:255] op_sel_hi:[1,0]
    v_pk_fma_f32 v[44:45], v[28:29], v[254:255], v[18:19] op_sel:[1,1,0] op_sel_hi:[0,1,1] neg_lo:[1,0,0]
    v_cvt_pk_bf16_f32 v80, v44, v45
    v_pk_mul_f32 v[18:19], v[44:45], v[248:249] op_sel_hi:[1,0]
    v_pk_fma_f32 v[44:45], v[44:45], v[248:249], v[18:19] op_sel:[1,1,0] op_sel_hi:[0,1,1] neg_lo:[1,0,0]
    v_cvt_pk_bf16_f32 v81, v44, v45
    v_pk_mul_f32 v[18:19], v[44:45], v[248:249] op_sel_hi:[1,0]
    v_pk_fma_f32 v[44:45], v[44:45], v[248:249], v[18:19] op_sel:[1,1,0] op_sel_hi:[0,1,1] neg_lo:[1,0,0]
    v_cvt_pk_bf16_f32 v82, v44, v45
    v_pk_mul_f32 v[18:19], v[44:45], v[248:249] op_sel_hi:[1,0]
    v_pk_fma_f32 v[44:45], v[44:45], v[248:249], v[18:19] op_sel:[1,1,0] op_sel_hi:[0,1,1] neg_lo:[1,0,0]
    v_cvt_pk_bf16_f32 v83, v44, v45
    v_pk_mul_f32 v[18:19], v[44:45], v[248:249] op_sel_hi:[1,0]
    v_pk_fma_f32 v[44:45], v[44:45], v[248:249], v[18:19] op_sel:[1,1,0] op_sel_hi:[0,1,1] neg_lo:[1,0,0]
    v_cvt_pk_bf16_f32 v84, v44, v45
    v_pk_mul_f32 v[18:19], v[44:45], v[248:249] op_sel_hi:[1,0]
    v_pk_fma_f32 v[44:45], v[44:45], v[248:249], v[18:19] op_sel:[1,1,0] op_sel_hi:[0,1,1] neg_lo:[1,0,0]
    v_cvt_pk_bf16_f32 v85, v44, v45
    v_pk_mul_f32 v[18:19], v[44:45], v[248:249] op_sel_hi:[1,0]
    v_pk_fma_f32 v[44:45], v[44:45], v[248:249], v[18:19] op_sel:[1,1,0] op_sel_hi:[0,1,1] neg_lo:[1,0,0]
    v_cvt_pk_bf16_f32 v86, v44, v45
    v_pk_mul_f32 v[18:19], v[44:45], v[248:249] op_sel_hi:[1,0]
    v_pk_fma_f32 v[44:45], v[44:45], v[248:249], v[18:19] op_sel:[1,1,0] op_sel_hi:[0,1,1] neg_lo:[1,0,0]
    v_cvt_pk_bf16_f32 v87, v44, v45
    v_pk_mul_f32 v[18:19], v[44:45], v[248:249] op_sel_hi:[1,0]
    v_pk_fma_f32 v[44:45], v[44:45], v[248:249], v[18:19] op_sel:[1,1,0] op_sel_hi:[0,1,1] neg_lo:[1,0,0]
    s_waitcnt lgkmcnt(0)
    v_mfma_f32_16x16x32_bf16 v[236:239], v[64:67], v[200:203], v[236:239]
    v_mfma_f32_16x16x32_bf16 v[236:239], v[68:71], v[204:207], v[236:239]
    v_mfma_f32_16x16x32_bf16 v[236:239], v[72:75], v[208:211], v[236:239]
    v_mfma_f32_16x16x32_bf16 v[236:239], v[76:79], v[212:215], v[236:239]
    ds_write_addtid_b32 v80 offset:0
    ds_write_addtid_b32 v81 offset:272
    ds_write_addtid_b32 v82 offset:544
    ds_write_addtid_b32 v83 offset:816
    ds_write_addtid_b32 v84 offset:1088
    ds_write_addtid_b32 v85 offset:1360
    ds_write_addtid_b32 v86 offset:1632
    ds_write_addtid_b32 v87 offset:1904
    v_cvt_pk_bf16_f32 v80, v44, v45
    ds_write_addtid_b32 v80 offset:2176
    ds_read_b128 v[216:219], v48 offset:0
    ds_read_b128 v[220:223], v48 offset:64
    ds_read_b128 v[224:227], v48 offset:128
    ds_read_b128 v[228:231], v48 offset:192
    v_add_u32 v48, s47, v9
    ds_write_b128 v48, v[232:235] offset:0
    ds_write_b128 v48, v[236:239] offset:1024
    s_waitcnt lgkmcnt(2)
    v_mfma_f32_16x16x32_bf16 v[240:243], v[216:219], v[200:203], v[240:243]
    v_mfma_f32_16x16x32_bf16 v[240:243], v[220:223], v[204:207], v[240:243]
    v_mfma_f32_16x16x32_bf16 v[240:243], v[224:227], v[208:211], v[240:243]
    v_mfma_f32_16x16x32_bf16 v[240:243], v[228:231], v[212:215], v[240:243]
    s_nop 7
    ds_write_b128 v48, v[240:243] offset:2048
    s_waitcnt lgkmcnt(0)
    v_mov_b32 v6, 163364
    v_mov_b32 v5, 1
    s_mov_b64 exec, 1
    ds_add_u32 v6, v5
    s_mov_b64 exec, -1
    s_lshl_b32 s70, s65, 3
    s_add_u32 s70, s70, s51
    s_lshl_b32 s40, s70, 9
    s_mul_i32 s71, s40, 56
    s_add_u32 s2, s71, 20971520
    s_add_u32 s40, s40, 327680
    s_sub_u32 s36, s2, 2097152
    s_sub_u32 s37, s2, 2089984
    s_sub_u32 s38, s2, 2082816
    s_sub_u32 s39, s2, 2075648
    s_lshl_b32 s46, s64, 1
    s_add_u32 s46, s46, s95
    s_lshr_b32 s70, s46, 4
    s_lshl_b32 s70, s70, 12
    s_add_u32 s100, s70, 17039360
    v_lshlrev_b32 v5, 7, v1
    s_add_u32 s70, s40, 16576512
    v_add_u32 v6, s70, v5
    v_add_u32 v5, s100, v5
    v_cmp_gt_u32 vcc, 32, v1
    s_nop 1
    v_cndmask_b32 v134, v6, v5, vcc
    s_mov_b32 exec_lo, -1
    s_mov_b32 exec_hi, 0xF
    s_mov_b32 s71, 0
    buffer_load_dword v2, v134, s[4:7], 0 offen sc1
    s_mov_b64 exec, -1
    s_mul_i32 s44, s95, 1600
    s_add_u32 s44, s44, 158592
    v_mad_u32_u16 v28, v52, 1, s44
    v_mad_u32_u16 v29, v52, 1, s44 op_sel:[1,0,0,0]
    v_mad_u32_u16 v30, v53, 1, s44
    v_mad_u32_u16 v31, v53, 1, s44 op_sel:[1,0,0,0]
    v_mad_u32_u16 v32, v54, 1, s44
    v_mad_u32_u16 v33, v54, 1, s44 op_sel:[1,0,0,0]
    v_mad_u32_u16 v34, v55, 1, s44
    v_mad_u32_u16 v35, v55, 1, s44 op_sel:[1,0,0,0]
    v_mad_u32_u16 v36, v56, 1, s44
    v_mad_u32_u16 v37, v56, 1, s44 op_sel:[1,0,0,0]
    v_mad_u32_u16 v38, v57, 1, s44
    v_mad_u32_u16 v39, v57, 1, s44 op_sel:[1,0,0,0]
    v_mad_u32_u16 v40, v58, 1, s44
    v_mad_u32_u16 v41, v58, 1, s44 op_sel:[1,0,0,0]
    v_mad_u32_u16 v42, v59, 1, s44
    v_mad_u32_u16 v43, v59, 1, s44 op_sel:[1,0,0,0]
    v_mad_u32_u16 v44, v60, 1, s44
    v_mad_u32_u16 v45, v60, 1, s44 op_sel:[1,0,0,0]
    v_mad_u32_u16 v46, v61, 1, s44
    v_mad_u32_u16 v47, v61, 1, s44 op_sel:[1,0,0,0]
    v_mad_u32_u16 v48, v62, 1, s44
    v_mad_u32_u16 v49, v62, 1, s44 op_sel:[1,0,0,0]
    v_mad_u32_u16 v50, v63, 1, s44
    v_mad_u32_u16 v51, v63, 1, s44 op_sel:[1,0,0,0]
    s_mul_i32 s70, s95, 4352
    s_add_u32 s70, s70, 132096
    v_add_u32 v18, s70, v9
    s_lshl_b32 s71, s93, 10
    v_add_u32 v19, s71, v18
    s_waitcnt lgkmcnt(0)
    v_mov_b32 v6, 163364
    s_mov_b32 s70, 0
ls_23:
    ds_read_b32 v5, v6
    s_add_u32 s70, s70, 1
    s_waitcnt lgkmcnt(0)
    v_readfirstlane_b32 s71, v5
    s_nop 0
    s_cmp_ge_u32 s71, 4
    s_nop 1
    s_cbranch_scc1 lsd_24
    s_cmp_lt_u32 s70, 3200000
    s_cbranch_scc1 ls_23
lsd_24:
    ds_read_b128 v[64:67], v19 offset:0
    ds_read_b128 v[68:71], v19 offset:8704
    ds_read_b128 v[80:83], v18 offset:2048
    ds_read_b128 v[84:87], v18 offset:10752
    v_lshl_add_u32 v18, v1, 3, s44
    s_lshl_b32 s71, s93, 9
    v_add_u32 v19, s71, v18
    v_mov_b32 v5, s44
    ds_write_b32 v5, v3 offset:1536
    s_waitcnt lgkmcnt(3)
    v_pk_add_f32 v[64:65], v[64:65], v[68:69]
    v_pk_add_f32 v[66:67], v[66:67], v[70:71]
    v_cvt_pk_bf16_f32 v68, v64, v65
    v_cvt_pk_bf16_f32 v69, v66, v67
    ds_write_b64 v19, v[68:69] offset:0
    s_waitcnt lgkmcnt(2)
    v_pk_add_f32 v[80:81], v[80:81], v[84:85]
    v_pk_add_f32 v[82:83], v[82:83], v[86:87]
    v_cvt_pk_bf16_f32 v84, v80, v81
    v_cvt_pk_bf16_f32 v85, v82, v83
    ds_write_b64 v18, v[84:85] offset:1024
    s_waitcnt lgkmcnt(0)
    v_mov_b32 v6, 163336
    s_mov_b32 s70, 0
    v_mov_b32 v5, 1
    s_mov_b64 exec, 1
    ds_add_u32 v6, v5
    s_mov_b64 exec, -1
ls_25:
    ds_read_b32 v5, v6
    s_add_u32 s70, s70, 1
    s_waitcnt lgkmcnt(0)
    v_readfirstlane_b32 s71, v5
    s_nop 0
    s_cmp_ge_u32 s71, 4
    s_nop 1
    s_cbranch_scc1 lsd_26
    s_cmp_lt_u32 s70, 3200000
    s_cbranch_scc1 ls_25
lsd_26:
    s_mov_b32 exec_lo, -1
    s_mov_b32 exec_hi, 0xF
    s_mov_b32 s71, 0
    s_waitcnt vmcnt(0)
    s_branch pollc_22
poll_20:
    buffer_load_dword v2, v134, s[4:7], 0 offen sc1
    s_add_u32 s71, s71, 1
    s_waitcnt vmcnt(0)
pollc_22:
    v_cmp_ne_u32 vcc, s50, v2
    s_nop 3
    s_cbranch_vccz polld_21
    s_cmp_lt_u32 s71, 400000
    s_cbranch_scc1 poll_20
polld_21:
    s_mov_b64 exec, -1
    s_lshl_b32 s70, s46, 12
    s_lshl_b32 s71, s93, 11
    s_add_u32 s70, s70, s71
    s_add_u32 s70, s70, 12582912
    buffer_load_dwordx4 v[20:23], v9, s[4:7], s70 offen offset:0 sc1
    buffer_load_dwordx4 v[24:27], v9, s[4:7], s70 offen offset:1024 sc1
    v_lshlrev_b32 v5, 2, v1
    buffer_load_dword v132, v5, s[4:7], s40 offen sc1
    buffer_load_dword v133, v5, s[4:7], s40 offen offset:256 sc1
    ds_read_u16 v64, v28
    ds_read_u16_d16_hi v29, v29
    ds_read_u16 v65, v30
    ds_read_u16_d16_hi v31, v31
    ds_read_u16 v66, v32
    ds_read_u16_d16_hi v33, v33
    ds_read_u16 v67, v34
    ds_read_u16_d16_hi v35, v35
    ds_read_u16 v68, v36
    ds_read_u16_d16_hi v37, v37
    ds_read_u16 v69, v38
    ds_read_u16_d16_hi v39, v39
    ds_read_u16 v72, v40
    ds_read_u16_d16_hi v41, v41
    ds_read_u16 v73, v42
    ds_read_u16_d16_hi v43, v43
    ds_read_u16 v74, v44
    ds_read_u16_d16_hi v45, v45
    ds_read_u16 v75, v46
    ds_read_u16_d16_hi v47, v47
    ds_read_u16 v76, v48
    ds_read_u16_d16_hi v49, v49
    ds_read_u16 v77, v50
    ds_read_u16_d16_hi v51, v51
    s_mul_i32 s70, s95, 16640
    s_add_u32 s45, s70, 114752
    s_lshl_b32 s71, s93, 10
    s_add_u32 s70, s45, s71
    v_add_u32 v18, s70, v9
    s_mul_i32 s47, s95, 5280
    s_add_u32 s47, s47, 148032
    v_lshrrev_b32 v5, 4, v1
    v_mul_u32_u24 v5, 4160, v5
    v_and_b32 v6, 15, v1
    v_lshl_add_u32 v5, v6, 2, v5
    v_add_u32 v5, s45, v5
    v_lshl_add_u32 v6, v1, 2, s47
    ds_write_b32 v5, v3 offset:4096
    s_mov_b32 exec_hi, 0xFF
    ds_write_b32 v6, v3
    s_mov_b32 exec_hi, -1
    v_lshlrev_b32 v6, 2, v1
    v_add_u32 v6, 114688, v6
    s_mov_b64 exec, 0xFFFF
    ds_write_b32 v6, v3
    s_mov_b64 exec, -1
    s_waitcnt lgkmcnt(15)
    v_or_b32 v64, v64, v29
    v_or_b32 v65, v65, v31
    v_or_b32 v66, v66, v33
    v_or_b32 v67, v67, v35
    v_or_b32 v68, v68, v37
    v_or_b32 v69, v69, v39
    v_mov_b32 v80, v65
    v_alignbit_b32 v84, v66, v65, 16
    v_alignbit_b32 v88, v65, v64, 16
    v_mov_b32 v81, v66
    v_alignbit_b32 v85, v67, v66, 16
    v_alignbit_b32 v89, v66, v65, 16
    v_mov_b32 v82, v67
    v_alignbit_b32 v86, v68, v67, 16
    v_alignbit_b32 v90, v67, v66, 16
    v_mov_b32 v83, v68
    v_alignbit_b32 v87, v69, v68, 16
    v_alignbit_b32 v91, v68, v67, 16
    ds_write_b128 v18, v[66:69] offset:0
    ds_write_b128 v18, v[84:87] offset:4160
    ds_write_b128 v18, v[80:83] offset:8320
    ds_write_b128 v18, v[88:91] offset:12480
    s_waitcnt lgkmcnt(7)
    v_or_b32 v72, v72, v41
    v_or_b32 v73, v73, v43
    v_or_b32 v74, v74, v45
    v_or_b32 v75, v75, v47
    v_or_b32 v76, v76, v49
    v_or_b32 v77, v77, v51
    v_mov_b32 v28, v73
    v_alignbit_b32 v32, v74, v73, 16
    v_alignbit_b32 v36, v73, v72, 16
    v_mov_b32 v29, v74
    v_alignbit_b32 v33, v75, v74, 16
    v_alignbit_b32 v37, v74, v73, 16
    v_mov_b32 v30, v75
    v_alignbit_b32 v34, v76, v75, 16
    v_alignbit_b32 v38, v75, v74, 16
    v_mov_b32 v31, v76
    v_alignbit_b32 v35, v77, v76, 16
    v_alignbit_b32 v39, v76, v75, 16
    ds_write_b128 v18, v[74:77] offset:2048
    ds_write_b128 v18, v[32:35] offset:6208
    ds_write_b128 v18, v[28:31] offset:10368
    ds_write_b128 v18, v[36:39] offset:14528
    v_lshrrev_b32 v5, 3, v1
    v_mul_u32_u24 v5, 160, v5
    v_and_b32 v7, 7, v1
    v_lshl_add_u32 v5, v7, 4, v5
    s_mul_i32 s70, s93, 2560
    s_add_u32 s70, s70, s47
    v_add_u32 v37, s70, v5
    v_and_b32 v5, 3, v1
    v_mul_u32_u24 v18, 4160, v5
    v_lshrrev_b32 v7, 4, v1
    v_lshl_add_u32 v18, v7, 4, v18
    v_bfe_u32 v5, v1, 2, 2
    v_lshlrev_b32 v5, 3, v5
    v_sub_u32 v18, v18, v5
    s_lshl_b32 s71, s93, 11
    s_sub_u32 s70, s45, s71
    s_add_u32 s70, s70, 2040
    v_add_u32 v19, s70, v18
    s_lshl_b32 s71, s93, 10
    s_sub_u32 s70, s45, s71
    s_add_u32 s70, s70, 3128
    v_add_u32 v18, s70, v18
    v_lshl_add_u32 v32, v7, 4, s47
    v_and_b32 v5, 15, v1
    v_mul_u32_u24 v5, 160, v5
    v_add_u32 v30, v32, v5
    v_and_b32 v7, 32, v1
    v_add_u32 v31, v30, v7
    v_lshlrev_b32 v7, 2, v7
    v_sub_u32 v33, v32, v7
    s_mul_i32 s70, s93, 1280
    s_sub_u32 s70, 1440, s70
    v_add_u32 v28, s70, v30
    v_add_u32 v29, s70, v31
    s_or_b32 s70, s51, 1
    s_lshl_b32 s70, s70, 12
    s_add_u32 s70, s70, 24576
    v_add_u32 v36, s70, v9
    s_waitcnt vmcnt(3)
    ds_write_b128 v37, v[20:23] offset:160
    s_waitcnt vmcnt(2)
    ds_write_b128 v37, v[24:27] offset:1440
    s_lshl_b32 s70, s95, 2
    s_add_u32 s48, s70, 163340
    s_waitcnt lgkmcnt(0)
    v_mov_b32 v6, s48
    s_mov_b32 s70, 0
    v_mov_b32 v5, 1
    s_mov_b64 exec, 1
    ds_add_u32 v6, v5
    s_mov_b64 exec, -1
ls_27:
    ds_read_b32 v5, v6
    s_add_u32 s70, s70, 1
    s_waitcnt lgkmcnt(0)
    v_readfirstlane_b32 s71, v5
    s_nop 0
    s_cmp_ge_u32 s71, 2
    s_nop 1
    s_cbranch_scc1 lsd_28
    s_cmp_lt_u32 s70, 3200000
    s_cbranch_scc1 ls_27
lsd_28:
    ds_read_b128 v[100:103], v31 offset:256
    ds_read_b128 v[96:99], v30 offset:224
    ds_read_b128 v[92:95], v30 offset:192
    ds_read_b128 v[88:91], v30 offset:160
    ds_read_b64 v[72:73], v19 offset:2048
    ds_read_b64 v[74:75], v19 offset:2056
    ds_read_b128 v[116:119], v31 offset:96
    ds_read_b128 v[112:115], v30 offset:64
    ds_read_b64 v[76:77], v19 offset:1984
    ds_read_b64 v[78:79], v19 offset:1992
    s_waitcnt lgkmcnt(4)
    v_mfma_f32_16x16x32_bf16 v[68:71], v[72:75], v[100:103], 0
    ds_read_b128 v[108:111], v30 offset:32
    v_mfma_f32_16x16x32_bf16 v[64:67], v[72:75], v[96:99], 0
    ds_read_b128 v[104:107], v30 offset:0
    v_mfma_f32_16x16x32_bf16 v[60:63], v[72:75], v[92:95], 0
    ds_read_b64 v[80:81], v19 offset:1920
    v_mfma_f32_16x16x32_bf16 v[56:59], v[72:75], v[88:91], 0
    ds_read_b64 v[82:83], v19 offset:1928
    s_waitcnt lgkmcnt(4)
    v_mfma_f32_16x16x32_bf16 v[68:71], v[76:79], v[92:95], v[68:71]
    v_subrev_u32 v35, 160, v31
    v_max_u32 v35, v35, v33
    ds_read_b128 v[100:103], v35 offset:96
    v_mfma_f32_16x16x32_bf16 v[64:67], v[76:79], v[88:91], v[64:67]
    v_subrev_u32 v34, 160, v30
    v_max_u32 v34, v34, v32
    ds_read_b128 v[96:99], v34 offset:64
    v_mfma_f32_16x16x32_bf16 v[60:63], v[76:79], v[116:119], v[60:63]
    ds_read_b64 v[84:85], v19 offset:1856
    v_mfma_f32_16x16x32_bf16 v[56:59], v[76:79], v[112:115], v[56:59]
    ds_read_b64 v[86:87], v19 offset:1864
    s_waitcnt lgkmcnt(4)
    v_mfma_f32_16x16x32_bf16 v[68:71], v[80:83], v[116:119], v[68:71]
    ds_read_b128 v[92:95], v34 offset:32
    v_mfma_f32_16x16x32_bf16 v[64:67], v[80:83], v[112:115], v[64:67]
    ds_read_b128 v[88:91], v34 offset:0
    v_mfma_f32_16x16x32_bf16 v[60:63], v[80:83], v[108:111], v[60:63]
    ds_read_b64 v[72:73], v19 offset:1792
    v_mfma_f32_16x16x32_bf16 v[56:59], v[80:83], v[104:107], v[56:59]
    ds_read_b64 v[74:75], v19 offset:1800
    s_waitcnt lgkmcnt(4)
    v_mfma_f32_16x16x32_bf16 v[68:71], v[84:87], v[108:111], v[68:71]
    v_subrev_u32 v35, 320, v31
    v_max_u32 v35, v35, v33
    ds_read_b128 v[116:119], v35 offset:96
    v_mfma_f32_16x16x32_bf16 v[64:67], v[84:87], v[104:107], v[64:67]
    v_subrev_u32 v34, 320, v30
    v_max_u32 v34, v34, v32
    ds_read_b128 v[112:115], v34 offset:64
    v_mfma_f32_16x16x32_bf16 v[60:63], v[84:87], v[100:103], v[60:63]
    ds_read_b64 v[76:77], v19 offset:1728
    v_mfma_f32_16x16x32_bf16 v[56:59], v[84:87], v[96:99], v[56:59]
    ds_read_b64 v[78:79], v19 offset:1736
    s_waitcnt lgkmcnt(4)
    v_mfma_f32_16x16x32_bf16 v[68:71], v[72:75], v[100:103], v[68:71]
    ds_read_b128 v[108:111], v34 offset:32
    v_mfma_f32_16x16x32_bf16 v[64:67], v[72:75], v[96:99], v[64:67]
    ds_read_b128 v[104:107], v34 offset:0
    v_mfma_f32_16x16x32_bf16 v[60:63], v[72:75], v[92:95], v[60:63]
    ds_read_b64 v[80:81], v19 offset:1664
    v_mfma_f32_16x16x32_bf16 v[56:59], v[72:75], v[88:91], v[56:59]
    ds_read_b64 v[82:83], v19 offset:1672
    s_waitcnt lgkmcnt(4)
    v_mfma_f32_16x16x32_bf16 v[68:71], v[76:79], v[92:95], v[68:71]
    v_subrev_u32 v35, 480, v31
    v_max_u32 v35, v35, v33
    ds_read_b128 v[100:103], v35 offset:96
    v_mfma_f32_16x16x32_bf16 v[64:67], v[76:79], v[88:91], v[64:67]
    v_subrev_u32 v34, 480, v30
    v_max_u32 v34, v34, v32
    ds_read_b128 v[96:99], v34 offset:64
    v_mfma_f32_16x16x32_bf16 v[60:63], v[76:79], v[116:119], v[60:63]
    ds_read_b64 v[84:85], v19 offset:1600
    v_mfma_f32_16x16x32_bf16 v[56:59], v[76:79], v[112:115], v[56:59]
    ds_read_b64 v[86:87], v19 offset:1608
    s_waitcnt lgkmcnt(4)
    v_mfma_f32_16x16x32_bf16 v[68:71], v[80:83], v[116:119], v[68:71]
    ds_read_b128 v[92:95], v34 offset:32
    v_mfma_f32_16x16x32_bf16 v[64:67], v[80:83], v[112:115], v[64:67]
    ds_read_b128 v[88:91], v34 offset:0
    v_mfma_f32_16x16x32_bf16 v[60:63], v[80:83], v[108:111], v[60:63]
    ds_read_b64 v[72:73], v19 offset:1536
    v_mfma_f32_16x16x32_bf16 v[56:59], v[80:83], v[104:107], v[56:59]
    ds_read_b64 v[74:75], v19 offset:1544
    s_waitcnt lgkmcnt(4)
    v_mfma_f32_16x16x32_bf16 v[68:71], v[84:87], v[108:111], v[68:71]
    v_subrev_u32 v35, 640, v31
    v_max_u32 v35, v35, v33
    ds_read_b128 v[116:119], v35 offset:96
    v_mfma_f32_16x16x32_bf16 v[64:67], v[84:87], v[104:107], v[64:67]
    v_subrev_u32 v34, 640, v30
    v_max_u32 v34, v34, v32
    ds_read_b128 v[112:115], v34 offset:64
    v_mfma_f32_16x16x32_bf16 v[60:63], v[84:87], v[100:103], v[60:63]
    ds_read_b64 v[76:77], v19 offset:1472
    v_mfma_f32_16x16x32_bf16 v[56:59], v[84:87], v[96:99], v[56:59]
    ds_read_b64 v[78:79], v19 offset:1480
    s_waitcnt lgkmcnt(4)
    v_mfma_f32_16x16x32_bf16 v[68:71], v[72:75], v[100:103], v[68:71]
    ds_read_b128 v[108:111], v34 offset:32
    v_mfma_f32_16x16x32_bf16 v[64:67], v[72:75], v[96:99], v[64:67]
    ds_read_b128 v[104:107], v34 offset:0
    v_mfma_f32_16x16x32_bf16 v[60:63], v[72:75], v[92:95], v[60:63]
    ds_read_b64 v[80:81], v19 offset:1408
    v_mfma_f32_16x16x32_bf16 v[56:59], v[72:75], v[88:91], v[56:59]
    ds_read_b64 v[82:83], v19 offset:1416
    s_waitcnt lgkmcnt(4)
    v_mfma_f32_16x16x32_bf16 v[68:71], v[76:79], v[92:95], v[68:71]
    v_subrev_u32 v35, 800, v31
    v_max_u32 v35, v35, v33
    ds_read_b128 v[100:103], v35 offset:96
    v_mfma_f32_16x16x32_bf16 v[64:67], v[76:79], v[88:91], v[64:67]
    v_subrev_u32 v34, 800, v30
    v_max_u32 v34, v34, v32
    ds_read_b128 v[96:99], v34 offset:64
    v_mfma_f32_16x16x32_bf16 v[60:63], v[76:79], v[116:119], v[60:63]
    ds_read_b64 v[84:85], v19 offset:1344
    v_mfma_f32_16x16x32_bf16 v[56:59], v[76:79], v[112:115], v[56:59]
    ds_read_b64 v[86:87], v19 offset:1352
    s_waitcnt lgkmcnt(4)
    v_mfma_f32_16x16x32_bf16 v[68:71], v[80:83], v[116:119], v[68:71]
    ds_read_b128 v[92:95], v34 offset:32
    v_mfma_f32_16x16x32_bf16 v[64:67], v[80:83], v[112:115], v[64:67]
    ds_read_b128 v[88:91], v34 offset:0
    v_mfma_f32_16x16x32_bf16 v[60:63], v[80:83], v[108:111], v[60:63]
    ds_read_b64 v[72:73], v19 offset:1280
    v_mfma_f32_16x16x32_bf16 v[56:59], v[80:83], v[104:107], v[56:59]
    ds_read_b64 v[74:75], v19 offset:1288
    s_waitcnt lgkmcnt(4)
    v_mfma_f32_16x16x32_bf16 v[68:71], v[84:87], v[108:111], v[68:71]
    v_subrev_u32 v35, 960, v31
    v_max_u32 v35, v35, v33
    ds_read_b128 v[116:119], v35 offset:96
    v_mfma_f32_16x16x32_bf16 v[64:67], v[84:87], v[104:107], v[64:67]
    v_subrev_u32 v34, 960, v30
    v_max_u32 v34, v34, v32
    ds_read_b128 v[112:115], v34 offset:64
    v_mfma_f32_16x16x32_bf16 v[60:63], v[84:87], v[100:103], v[60:63]
    ds_read_b64 v[76:77], v19 offset:1216
    v_mfma_f32_16x16x32_bf16 v[56:59], v[84:87], v[96:99], v[56:59]
    ds_read_b64 v[78:79], v19 offset:1224
    s_waitcnt lgkmcnt(4)
    v_mfma_f32_16x16x32_bf16 v[68:71], v[72:75], v[100:103], v[68:71]
    ds_read_b128 v[108:111], v34 offset:32
    v_mfma_f32_16x16x32_bf16 v[64:67], v[72:75], v[96:99], v[64:67]
    ds_read_b128 v[104:107], v34 offset:0
    v_mfma_f32_16x16x32_bf16 v[60:63], v[72:75], v[92:95], v[60:63]
    ds_read_b64 v[80:81], v19 offset:1152
    v_mfma_f32_16x16x32_bf16 v[56:59], v[72:75], v[88:91], v[56:59]
    ds_read_b64 v[82:83], v19 offset:1160
    s_waitcnt lgkmcnt(4)
    v_mfma_f32_16x16x32_bf16 v[68:71], v[76:79], v[92:95], v[68:71]
    v_subrev_u32 v35, 1120, v31
    v_max_u32 v35, v35, v33
    ds_read_b128 v[100:103], v35 offset:96
    v_mfma_f32_16x16x32_bf16 v[64:67], v[76:79], v[88:91], v[64:67]
    v_subrev_u32 v34, 1120, v30
    v_max_u32 v34, v34, v32
    ds_read_b128 v[96:99], v34 offset:64
    v_mfma_f32_16x16x32_bf16 v[60:63], v[76:79], v[116:119], v[60:63]
    ds_read_b64 v[84:85], v19 offset:1088
    v_mfma_f32_16x16x32_bf16 v[56:59], v[76:79], v[112:115], v[56:59]
    ds_read_b64 v[86:87], v19 offset:1096
    s_waitcnt lgkmcnt(4)
    v_mfma_f32_16x16x32_bf16 v[68:71], v[80:83], v[116:119], v[68:71]
    ds_read_b128 v[92:95], v34 offset:32
    v_mfma_f32_16x16x32_bf16 v[64:67], v[80:83], v[112:115], v[64:67]
    ds_read_b128 v[88:91], v34 offset:0
    v_mfma_f32_16x16x32_bf16 v[60:63], v[80:83], v[108:111], v[60:63]
    ds_read_b64 v[72:73], v19 offset:1024
    v_mfma_f32_16x16x32_bf16 v[56:59], v[80:83], v[104:107], v[56:59]
    ds_read_b64 v[74:75], v19 offset:1032
    s_waitcnt lgkmcnt(4)
    v_mfma_f32_16x16x32_bf16 v[68:71], v[84:87], v[108:111], v[68:71]
    v_subrev_u32 v35, 1280, v31
    v_max_u32 v35, v35, v33
    ds_read_b128 v[116:119], v35 offset:96
    v_mfma_f32_16x16x32_bf16 v[64:67], v[84:87], v[104:107], v[64:67]
    v_subrev_u32 v34, 1280, v30
    v_max_u32 v34, v34, v32
    ds_read_b128 v[112:115], v34 offset:64
    v_mfma_f32_16x16x32_bf16 v[60:63], v[84:87], v[100:103], v[60:63]
    ds_read_b64 v[76:77], v19 offset:960
    v_mfma_f32_16x16x32_bf16 v[56:59], v[84:87], v[96:99], v[56:59]
    ds_read_b64 v[78:79], v19 offset:968
    s_waitcnt lgkmcnt(4)
    v_mfma_f32_16x16x32_bf16 v[68:71], v[72:75], v[100:103], v[68:71]
    ds_read_b128 v[108:111], v34 offset:32
    v_mfma_f32_16x16x32_bf16 v[64:67], v[72:75], v[96:99], v[64:67]
    ds_read_b128 v[104:107], v34 offset:0
    v_mfma_f32_16x16x32_bf16 v[60:63], v[72:75], v[92:95], v[60:63]
    ds_read_b64 v[80:81], v19 offset:896
    v_mfma_f32_16x16x32_bf16 v[56:59], v[72:75], v[88:91], v[56:59]
    ds_read_b64 v[82:83], v19 offset:904
    s_waitcnt lgkmcnt(4)
    v_mfma_f32_16x16x32_bf16 v[68:71], v[76:79], v[92:95], v[68:71]
    v_subrev_u32 v35, 1440, v31
    v_max_u32 v35, v35, v33
    ds_read_b128 v[100:103], v35 offset:96
    v_mfma_f32_16x16x32_bf16 v[64:67], v[76:79], v[88:91], v[64:67]
    v_subrev_u32 v34, 1440, v30
    v_max_u32 v34, v34, v32
    ds_read_b128 v[96:99], v34 offset:64
    v_mfma_f32_16x16x32_bf16 v[60:63], v[76:79], v[116:119], v[60:63]
    ds_read_b64 v[84:85], v19 offset:832
    v_mfma_f32_16x16x32_bf16 v[56:59], v[76:79], v[112:115], v[56:59]
    ds_read_b64 v[86:87], v19 offset:840
    s_waitcnt lgkmcnt(4)
    v_mfma_f32_16x16x32_bf16 v[68:71], v[80:83], v[116:119], v[68:71]
    ds_read_b128 v[92:95], v34 offset:32
    v_mfma_f32_16x16x32_bf16 v[64:67], v[80:83], v[112:115], v[64:67]
    ds_read_b128 v[88:91], v34 offset:0
    v_mfma_f32_16x16x32_bf16 v[60:63], v[80:83], v[108:111], v[60:63]
    ds_read_b64 v[72:73], v19 offset:768
    v_mfma_f32_16x16x32_bf16 v[56:59], v[80:83], v[104:107], v[56:59]
    ds_read_b64 v[74:75], v19 offset:776
    s_waitcnt lgkmcnt(4)
    v_mfma_f32_16x16x32_bf16 v[68:71], v[84:87], v[108:111], v[68:71]
    v_subrev_u32 v35, 1600, v31
    v_max_u32 v35, v35, v33
    ds_read_b128 v[116:119], v35 offset:96
    v_mfma_f32_16x16x32_bf16 v[64:67], v[84:87], v[104:107], v[64:67]
    v_subrev_u32 v34, 1600, v30
    v_max_u32 v34, v34, v32
    ds_read_b128 v[112:115], v34 offset:64
    v_mfma_f32_16x16x32_bf16 v[60:63], v[84:87], v[100:103], v[60:63]
    ds_read_b64 v[76:77], v19 offset:704
    v_mfma_f32_16x16x32_bf16 v[56:59], v[84:87], v[96:99], v[56:59]
    ds_read_b64 v[78:79], v19 offset:712
    s_waitcnt lgkmcnt(4)
    v_mfma_f32_16x16x32_bf16 v[68:71], v[72:75], v[100:103], v[68:71]
    ds_read_b128 v[108:111], v34 offset:32
    v_mfma_f32_16x16x32_bf16 v[64:67], v[72:75], v[96:99], v[64:67]
    ds_read_b128 v[104:107], v34 offset:0
    v_mfma_f32_16x16x32_bf16 v[60:63], v[72:75], v[92:95], v[60:63]
    ds_read_b64 v[80:81], v19 offset:640
    v_mfma_f32_16x16x32_bf16 v[56:59], v[72:75], v[88:91], v[56:59]
    ds_read_b64 v[82:83], v19 offset:648
    s_waitcnt lgkmcnt(4)
    v_mfma_f32_16x16x32_bf16 v[68:71], v[76:79], v[92:95], v[68:71]
    v_subrev_u32 v35, 1760, v31
    v_max_u32 v35, v35, v33
    ds_read_b128 v[100:103], v35 offset:96
    v_mfma_f32_16x16x32_bf16 v[64:67], v[76:79], v[88:91], v[64:67]
    v_subrev_u32 v34, 1760, v30
    v_max_u32 v34, v34, v32
    ds_read_b128 v[96:99], v34 offset:64
    v_mfma_f32_16x16x32_bf16 v[60:63], v[76:79], v[116:119], v[60:63]
    ds_read_b64 v[84:85], v19 offset:576
    v_mfma_f32_16x16x32_bf16 v[56:59], v[76:79], v[112:115], v[56:59]
    ds_read_b64 v[86:87], v19 offset:584
    s_waitcnt lgkmcnt(4)
    v_mfma_f32_16x16x32_bf16 v[68:71], v[80:83], v[116:119], v[68:71]
    ds_read_b128 v[92:95], v34 offset:32
    v_mfma_f32_16x16x32_bf16 v[64:67], v[80:83], v[112:115], v[64:67]
    ds_read_b128 v[88:91], v34 offset:0
    v_mfma_f32_16x16x32_bf16 v[60:63], v[80:83], v[108:111], v[60:63]
    ds_read_b64 v[72:73], v19 offset:512
    v_mfma_f32_16x16x32_bf16 v[56:59], v[80:83], v[104:107], v[56:59]
    ds_read_b64 v[74:75], v19 offset:520
    s_waitcnt lgkmcnt(4)
    v_mfma_f32_16x16x32_bf16 v[68:71], v[84:87], v[108:111], v[68:71]
    v_subrev_u32 v35, 1920, v31
    v_max_u32 v35, v35, v33
    ds_read_b128 v[116:119], v35 offset:96
    v_mfma_f32_16x16x32_bf16 v[64:67], v[84:87], v[104:107], v[64:67]
    v_subrev_u32 v34, 1920, v30
    v_max_u32 v34, v34, v32
    ds_read_b128 v[112:115], v34 offset:64
    v_mfma_f32_16x16x32_bf16 v[60:63], v[84:87], v[100:103], v[60:63]
    ds_read_b64 v[76:77], v19 offset:448
    v_mfma_f32_16x16x32_bf16 v[56:59], v[84:87], v[96:99], v[56:59]
    ds_read_b64 v[78:79], v19 offset:456
    s_waitcnt lgkmcnt(4)
    v_mfma_f32_16x16x32_bf16 v[68:71], v[72:75], v[100:103], v[68:71]
    ds_read_b128 v[108:111], v34 offset:32
    v_mfma_f32_16x16x32_bf16 v[64:67], v[72:75], v[96:99], v[64:67]
    ds_read_b128 v[104:107], v34 offset:0
    v_mfma_f32_16x16x32_bf16 v[60:63], v[72:75], v[92:95], v[60:63]
    ds_read_b64 v[80:81], v19 offset:384
    v_mfma_f32_16x16x32_bf16 v[56:59], v[72:75], v[88:91], v[56:59]
    ds_read_b64 v[82:83], v19 offset:392
    s_waitcnt lgkmcnt(4)
    v_mfma_f32_16x16x32_bf16 v[68:71], v[76:79], v[92:95], v[68:71]
    v_subrev_u32 v35, 2080, v31
    v_max_u32 v35, v35, v33
    ds_read_b128 v[100:103], v35 offset:96
    v_mfma_f32_16x16x32_bf16 v[64:67], v[76:79], v[88:91], v[64:67]
    v_subrev_u32 v34, 2080, v30
    v_max_u32 v34, v34, v32
    ds_read_b128 v[96:99], v34 offset:64
    v_mfma_f32_16x16x32_bf16 v[60:63], v[76:79], v[116:119], v[60:63]
    ds_read_b64 v[84:85], v19 offset:320
    v_mfma_f32_16x16x32_bf16 v[56:59], v[76:79], v[112:115], v[56:59]
    ds_read_b64 v[86:87], v19 offset:328
    s_waitcnt lgkmcnt(4)
    v_mfma_f32_16x16x32_bf16 v[68:71], v[80:83], v[116:119], v[68:71]
    ds_read_b128 v[92:95], v34 offset:32
    v_mfma_f32_16x16x32_bf16 v[64:67], v[80:83], v[112:115], v[64:67]
    ds_read_b128 v[88:91], v34 offset:0
    v_mfma_f32_16x16x32_bf16 v[60:63], v[80:83], v[108:111], v[60:63]
    ds_read_b64 v[72:73], v19 offset:256
    v_mfma_f32_16x16x32_bf16 v[56:59], v[80:83], v[104:107], v[56:59]
    ds_read_b64 v[74:75], v19 offset:264
    s_waitcnt lgkmcnt(4)
    v_mfma_f32_16x16x32_bf16 v[68:71], v[84:87], v[108:111], v[68:71]
    v_subrev_u32 v35, 2240, v31
    v_max_u32 v35, v35, v33
    ds_read_b128 v[116:119], v35 offset:96
    v_mfma_f32_16x16x32_bf16 v[64:67], v[84:87], v[104:107], v[64:67]
    v_subrev_u32 v34, 2240, v30
    v_max_u32 v34, v34, v32
    ds_read_b128 v[112:115], v34 offset:64
    v_mfma_f32_16x16x32_bf16 v[60:63], v[84:87], v[100:103], v[60:63]
    ds_read_b64 v[76:77], v19 offset:192
    v_mfma_f32_16x16x32_bf16 v[56:59], v[84:87], v[96:99], v[56:59]
    ds_read_b64 v[78:79], v19 offset:200
    s_waitcnt lgkmcnt(4)
    v_mfma_f32_16x16x32_bf16 v[68:71], v[72:75], v[100:103], v[68:71]
    ds_read_b128 v[108:111], v34 offset:32
    v_mfma_f32_16x16x32_bf16 v[64:67], v[72:75], v[96:99], v[64:67]
    ds_read_b128 v[104:107], v34 offset:0
    v_mfma_f32_16x16x32_bf16 v[60:63], v[72:75], v[92:95], v[60:63]
    ds_read_b64 v[80:81], v19 offset:128
    v_mfma_f32_16x16x32_bf16 v[56:59], v[72:75], v[88:91], v[56:59]
    ds_read_b64 v[82:83], v19 offset:136
    s_waitcnt lgkmcnt(4)
    v_mfma_f32_16x16x32_bf16 v[68:71], v[76:79], v[92:95], v[68:71]
    v_subrev_u32 v35, 2400, v31
    v_max_u32 v35, v35, v33
    ds_read_b128 v[100:103], v35 offset:96
    v_mfma_f32_16x16x32_bf16 v[64:67], v[76:79], v[88:91], v[64:67]
    ds_read_b64 v[84:85], v19 offset:64
    v_mfma_f32_16x16x32_bf16 v[60:63], v[76:79], v[116:119], v[60:63]
    ds_read_b64 v[86:87], v19 offset:72
    v_mfma_f32_16x16x32_bf16 v[56:59], v[76:79], v[112:115], v[56:59]
    s_waitcnt lgkmcnt(3)
    v_mfma_f32_16x16x32_bf16 v[68:71], v[80:83], v[116:119], v[68:71]
    ds_read_b64 v[72:73], v19 offset:0
    v_mfma_f32_16x16x32_bf16 v[64:67], v[80:83], v[112:115], v[64:67]
    ds_read_b64 v[74:75], v19 offset:8
    v_mfma_f32_16x16x32_bf16 v[60:63], v[80:83], v[108:111], v[60:63]
    v_mfma_f32_16x16x32_bf16 v[56:59], v[80:83], v[104:107], v[56:59]
    s_waitcnt lgkmcnt(2)
    v_mfma_f32_16x16x32_bf16 v[68:71], v[84:87], v[108:111], v[68:71]
    v_mfma_f32_16x16x32_bf16 v[64:67], v[84:87], v[104:107], v[64:67]
    v_mfma_f32_16x16x32_bf16 v[60:63], v[84:87], v[100:103], v[60:63]
    s_waitcnt lgkmcnt(0)
    v_mfma_f32_16x16x32_bf16 v[68:71], v[72:75], v[100:103], v[68:71]
    v_add_u32 v36, s99, v9
    s_nop 0
    ds_write_b128 v36, v[56:59] offset:0
    s_nop 2
    ds_write_b128 v36, v[60:63] offset:1024
    ds_write_b128 v36, v[64:67] offset:2048
    ds_write_b128 v36, v[68:71] offset:3072
    v_mov_b32 v6, 163452
    v_mov_b32 v5, 1
    s_mov_b64 exec, 1
    ds_add_u32 v6, v5
    s_mov_b64 exec, -1
    s_setprio 0
    s_mul_i32 s70, s3, 224
    s_mul_i32 s71, s94, 56
    s_add_u32 s70, s70, s71
    v_add_u32 v5, s70, v1
    v_mul_u32_u24 v6, 9363, v5
    v_lshrrev_b32 v6, 20, v6
    v_mul_u32_u24 v6, 112, v6
    v_add_lshl_u32 v142, v5, v6, 7
    s_waitcnt vmcnt(0)
    s_mov_b32 s70, s36
    buffer_load_dwordx4 v[144:147], v9, s[4:7], s70 offen offset:0 sc1
    s_mov_b32 s70, s36
    buffer_load_dwordx4 v[148:151], v9, s[4:7], s70 offen offset:1024 sc1
    s_mov_b32 s70, s36
    buffer_load_dwordx4 v[152:155], v9, s[4:7], s70 offen offset:2048 sc1
    s_mov_b32 s70, s36
    buffer_load_dwordx4 v[156:159], v9, s[4:7], s70 offen offset:3072 sc1
    s_add_u32 s70, s36, 4096
    buffer_load_dwordx4 v[160:163], v9, s[4:7], s70 offen offset:0 sc1
    s_add_u32 s70, s36, 4096
    buffer_load_dwordx4 v[164:167], v9, s[4:7], s70 offen offset:1024 sc1
    s_add_u32 s70, s36, 4096
    buffer_load_dwordx4 v[168:171], v9, s[4:7], s70 offen offset:2048 sc1
    s_mov_b32 s70, s37
    buffer_load_dwordx4 v[172:175], v9, s[4:7], s70 offen offset:0 sc1
    s_mov_b32 s70, s37
    buffer_load_dwordx4 v[176:179], v9, s[4:7], s70 offen offset:1024 sc1
    s_mov_b32 s70, s37
    buffer_load_dwordx4 v[180:183], v9, s[4:7], s70 offen offset:2048 sc1
    s_mov_b32 s70, s37
    buffer_load_dwordx4 v[184:187], v9, s[4:7], s70 offen offset:3072 sc1
    s_add_u32 s70, s37, 4096
    buffer_load_dwordx4 v[188:191], v9, s[4:7], s70 offen offset:0 sc1
    s_add_u32 s70, s37, 4096
    buffer_load_dwordx4 v[192:195], v9, s[4:7], s70 offen offset:1024 sc1
    s_add_u32 s70, s37, 4096
    buffer_load_dwordx4 v[196:199], v9, s[4:7], s70 offen offset:2048 sc1
    s_mov_b32 s70, s38
    buffer_load_dwordx4 v[200:203], v9, s[4:7], s70 offen offset:0 sc1
    s_mov_b32 s70, s38
    buffer_load_dwordx4 v[204:207], v9, s[4:7], s70 offen offset:1024 sc1
    s_mov_b32 s70, s38
    buffer_load_dwordx4 v[208:211], v9, s[4:7], s70 offen offset:2048 sc1
    s_mov_b32 s70, s38
    buffer_load_dwordx4 v[212:215], v9, s[4:7], s70 offen offset:3072 sc1
    s_add_u32 s70, s38, 4096
    buffer_load_dwordx4 v[216:219], v9, s[4:7], s70 offen offset:0 sc1
    s_add_u32 s70, s38, 4096
    buffer_load_dwordx4 v[220:223], v9, s[4:7], s70 offen offset:1024 sc1
    s_waitcnt lgkmcnt(0)
L_g3:
    v_add_u32 v136, 57344, v9
    v_and_b32 v7, 31, v1
    v_lshlrev_b32 v7, 2, v7
    v_add_u32 v7, 161792, v7
    s_mul_i32 s44, s66, 224
    s_lshl_b32 s70, s65, 3
    s_add_u32 s92, s70, s51
    s_lshl_b32 s71, s92, 1
    s_add_u32 s71, s44, s71
    s_lshl_b32 s93, s71, 10
    s_add_u32 s93, s93, 5242880
    s_mul_i32 s70, s51, 14
    s_add_u32 s44, s44, s70
    s_lshl_b32 s44, s44, 10
    s_add_u32 s44, s44, 5242880
    s_mul_i32 s45, s66, 7168
    s_lshl_b32 s70, s92, 7
    s_add_u32 s46, s45, s70
    s_add_u32 s47, s46, 17563648
    s_add_u32 s46, s46, 17301504
    s_mul_i32 s70, s51, 896
    s_add_u32 s45, s45, s70
    s_waitcnt lgkmcnt(0)
    v_mov_b32 v6, 163328
    s_mov_b32 s70, 0
ls_29:
    ds_read_b32 v5, v6
    s_add_u32 s70, s70, 1
    s_waitcnt lgkmcnt(0)
    v_readfirstlane_b32 s71, v5
    s_nop 0
    s_cmp_ge_u32 s71, 4
    s_nop 1
    s_cbranch_scc1 lsd_30
    s_cmp_lt_u32 s70, 3200000
    s_cbranch_scc1 ls_29
lsd_30:
    s_setprio 3
    s_cmp_lt_u32 s51, 4
    s_cbranch_scc1 pr_31
    s_setprio 2
pr_31:
    ds_read_b128 v[28:31], v136 offset:0
    ds_read_b128 v[32:35], v136 offset:1024
    ds_read_b128 v[36:39], v136 offset:2048
    ds_read_b128 v[40:43], v136 offset:3072
    ds_read_b128 v[44:47], v136 offset:4096
    ds_read_b128 v[48:51], v136 offset:5120
    ds_read_b128 v[52:55], v136 offset:6144
    ds_read2st64_b32 v[68:69], v7 offset0:0 offset1:1
    ds_read2_b32 v[70:71], v7 offset0:32 offset1:96
    v_mov_b32 v6, 163456
    ds_read_b32 v5, v6
    s_cmp_ge_u32 s51, 4
    s_cbranch_scc1 m0s_32
    s_waitcnt vmcnt(1)
    s_waitcnt lgkmcnt(9)
    v_mfma_f32_32x32x16_bf16 v[12:27], v[144:147], v[28:31], 0
    ds_read_b128 v[56:59], v136 offset:7168
    s_waitcnt lgkmcnt(9)
    v_mfma_f32_32x32x16_bf16 v[12:27], v[148:151], v[32:35], v[12:27]
    ds_read_b128 v[28:31], v136 offset:8192
    s_waitcnt lgkmcnt(9)
    v_mfma_f32_32x32x16_bf16 v[12:27], v[152:155], v[36:39], v[12:27]
    ds_read_b128 v[32:35], v136 offset:9216
    s_waitcnt lgkmcnt(9)
    v_mfma_f32_32x32x16_bf16 v[12:27], v[156:159], v[40:43], v[12:27]
    ds_read_b128 v[36:39], v136 offset:10240
    s_waitcnt lgkmcnt(9)
    v_mfma_f32_32x32x16_bf16 v[12:27], v[160:163], v[44:47], v[12:27]
    ds_read_b128 v[40:43], v136 offset:11264
    s_waitcnt lgkmcnt(9)
    v_mfma_f32_32x32x16_bf16 v[12:27], v[164:167], v[48:51], v[12:27]
    ds_read_b128 v[44:47], v136 offset:12288
    s_waitcnt lgkmcnt(9)
    v_mfma_f32_32x32x16_bf16 v[12:27], v[168:171], v[52:55], v[12:27]
    ds_read_b128 v[48:51], v136 offset:13312
    s_waitcnt lgkmcnt(6)
    v_mfma_f32_32x32x16_bf16 v[12:27], v[172:175], v[56:59], v[12:27]
    ds_read_b128 v[52:55], v136 offset:14336
    s_waitcnt lgkmcnt(6)
    v_mfma_f32_32x32x16_bf16 v[12:27], v[176:179], v[28:31], v[12:27]
    ds_read_b128 v[56:59], v136 offset:15360
    s_waitcnt lgkmcnt(6)
    v_mfma_f32_32x32x16_bf16 v[12:27], v[180:183], v[32:35], v[12:27]
    ds_read_b128 v[28:31], v136 offset:16384
    s_waitcnt lgkmcnt(6)
    v_mfma_f32_32x32x16_bf16 v[12:27], v[184:187], v[36:39], v[12:27]
    ds_read_b128 v[32:35], v136 offset:17408
    v_readfirstlane_b32 s33, v5
    s_waitcnt lgkmcnt(6)
    v_mfma_f32_32x32x16_bf16 v[12:27], v[188:191], v[40:43], v[12:27]
    ds_read_b128 v[36:39], v136 offset:18432
    s_waitcnt lgkmcnt(6)
    v_mfma_f32_32x32x16_bf16 v[12:27], v[192:195], v[44:47], v[12:27]
    ds_read_b128 v[40:43], v136 offset:19456
    s_waitcnt lgkmcnt(6)
    v_mfma_f32_32x32x16_bf16 v[12:27], v[196:199], v[48:51], v[12:27]
    ds_read_b128 v[44:47], v136 offset:20480
    s_waitcnt lgkmcnt(6)
    v_mfma_f32_32x32x16_bf16 v[12:27], v[200:203], v[52:55], v[12:27]
    ds_read_b128 v[48:51], v136 offset:21504
    s_waitcnt lgkmcnt(6)
    v_mfma_f32_32x32x16_bf16 v[12:27], v[204:207], v[56:59], v[12:27]
    ds_read_b128 v[52:55], v136 offset:22528
    s_waitcnt lgkmcnt(6)
    v_mfma_f32_32x32x16_bf16 v[12:27], v[208:211], v[28:31], v[12:27]
    ds_read_b128 v[56:59], v136 offset:23552
    s_waitcnt lgkmcnt(6)
    v_mfma_f32_32x32x16_bf16 v[12:27], v[212:215], v[32:35], v[12:27]
    ds_read_b128 v[28:31], v136 offset:24576
    s_waitcnt lgkmcnt(6)
    v_mfma_f32_32x32x16_bf16 v[12:27], v[216:219], v[36:39], v[12:27]
    ds_read_b128 v[32:35], v136 offset:25600
    s_waitcnt lgkmcnt(6)
    v_mfma_f32_32x32x16_bf16 v[12:27], v[220:223], v[40:43], v[12:27]
    ds_read_b128 v[36:39], v136 offset:26624
    s_waitcnt lgkmcnt(6)
    v_mfma_f32_32x32x16_bf16 v[12:27], v[224:227], v[44:47], v[12:27]
    ds_read_b128 v[40:43], v136 offset:27648
    s_waitcnt lgkmcnt(6)
    v_mfma_f32_32x32x16_bf16 v[12:27], v[228:231], v[48:51], v[12:27]
    s_waitcnt lgkmcnt(5)
    v_mfma_f32_32x32x16_bf16 v[12:27], v[232:235], v[52:55], v[12:27]
    s_waitcnt lgkmcnt(4)
    v_mfma_f32_32x32x16_bf16 v[12:27], v[236:239], v[56:59], v[12:27]
    v_cvt_pk_bf16_f32 v72, -v68, -v68
    v_lshlrev_b32 v60, 16, v72
    v_add_f32 v60, v68, v60
    v_cvt_pk_bf16_f32 v73, -v60, 0
    s_waitcnt lgkmcnt(3)
    v_mfma_f32_32x32x16_bf16 v[12:27], v[240:243], v[28:31], v[12:27]
    s_waitcnt lgkmcnt(2)
    v_mfma_f32_32x32x16_bf16 v[12:27], v[244:247], v[32:35], v[12:27]
    v_rcp_f32 v60, v69
    s_nop 0
    v_mul_f32 v10, 3222493025, v60
    v_mul_f32 v11, v60, v60
    v_mul_f32 v11, v11, v60
    v_mul_f32 v11, 3184710632, v11
    s_waitcnt lgkmcnt(1)
    v_mfma_f32_32x32x16_bf16 v[12:27], v[248:251], v[36:39], v[12:27]
    s_waitcnt lgkmcnt(0)
    v_mfma_f32_32x32x16_bf16 v[12:27], v[252:255], v[40:43], v[12:27]
    v_add_f32 v132, v132, v133
    v_cvt_pk_bf16_f32 v60, v132, v132
    v_lshlrev_b32 v61, 16, v60
    v_sub_f32 v61, v132, v61
    v_cvt_pk_bf16_f32 v74, v132, v61
    v_and_b32 v75, 0xffff, v60
    v_mov_b32 v76, 0
    v_mov_b32 v77, 0
    s_nop 2
    s_branch m0j_33
m0s_32:
    s_waitcnt lgkmcnt(9)
    s_waitcnt vmcnt(19)
    v_mfma_f32_32x32x16_bf16 v[12:27], v[144:147], v[28:31], 0
    ds_read_b128 v[56:59], v136 offset:7168
    s_add_u32 s70, s38, 4096
    buffer_load_dwordx4 v[224:227], v9, s[4:7], s70 offen offset:2048 sc1
    s_waitcnt lgkmcnt(9)
    s_waitcnt vmcnt(19)
    v_mfma_f32_32x32x16_bf16 v[12:27], v[148:151], v[32:35], v[12:27]
    ds_read_b128 v[28:31], v136 offset:8192
    s_mov_b32 s70, s39
    buffer_load_dwordx4 v[228:231], v9, s[4:7], s70 offen offset:0 sc1
    s_waitcnt lgkmcnt(9)
    s_waitcnt vmcnt(19)
    v_mfma_f32_32x32x16_bf16 v[12:27], v[152:155], v[36:39], v[12:27]
    ds_read_b128 v[32:35], v136 offset:9216
    s_mov_b32 s70, s39
    buffer_load_dwordx4 v[232:235], v9, s[4:7], s70 offen offset:1024 sc1
    s_waitcnt lgkmcnt(9)
    s_waitcnt vmcnt(19)
    v_mfma_f32_32x32x16_bf16 v[12:27], v[156:159], v[40:43], v[12:27]
    ds_read_b128 v[36:39], v136 offset:10240
    s_mov_b32 s70, s39
    buffer_load_dwordx4 v[236:239], v9, s[4:7], s70 offen offset:2048 sc1
    s_waitcnt lgkmcnt(9)
    s_waitcnt vmcnt(19)
    v_mfma_f32_32x32x16_bf16 v[12:27], v[160:163], v[44:47], v[12:27]
    ds_read_b128 v[40:43], v136 offset:11264
    s_mov_b32 s70, s39
    buffer_load_dwordx4 v[240:243], v9, s[4:7], s70 offen offset:3072 sc1
    s_waitcnt lgkmcnt(9)
    s_waitcnt vmcnt(19)
    v_mfma_f32_32x32x16_bf16 v[12:27], v[164:167], v[48:51], v[12:27]
    ds_read_b128 v[44:47], v136 offset:12288
    s_add_u32 s70, s39, 4096
    buffer_load_dwordx4 v[244:247], v9, s[4:7], s70 offen offset:0 sc1
    s_waitcnt lgkmcnt(9)
    s_waitcnt vmcnt(19)
    v_mfma_f32_32x32x16_bf16 v[12:27], v[168:171], v[52:55], v[12:27]
    ds_read_b128 v[48:51], v136 offset:13312
    s_add_u32 s70, s39, 4096
    buffer_load_dwordx4 v[248:251], v9, s[4:7], s70 offen offset:1024 sc1
    s_waitcnt lgkmcnt(6)
    s_waitcnt vmcnt(19)
    v_mfma_f32_32x32x16_bf16 v[12:27], v[172:175], v[56:59], v[12:27]
    ds_read_b128 v[52:55], v136 offset:14336
    s_add_u32 s70, s39, 4096
    buffer_load_dwordx4 v[252:255], v9, s[4:7], s70 offen offset:2048 sc1
    s_waitcnt lgkmcnt(6)
    s_waitcnt vmcnt(19)
    v_mfma_f32_32x32x16_bf16 v[12:27], v[176:179], v[28:31], v[12:27]
    ds_read_b128 v[56:59], v136 offset:15360
    s_waitcnt lgkmcnt(6)
    s_waitcnt vmcnt(18)
    v_mfma_f32_32x32x16_bf16 v[12:27], v[180:183], v[32:35], v[12:27]
    ds_read_b128 v[28:31], v136 offset:16384
    s_waitcnt lgkmcnt(6)
    s_waitcnt vmcnt(17)
    v_mfma_f32_32x32x16_bf16 v[12:27], v[184:187], v[36:39], v[12:27]
    ds_read_b128 v[32:35], v136 offset:17408
    v_readfirstlane_b32 s33, v5
    s_waitcnt lgkmcnt(6)
    s_waitcnt vmcnt(16)
    v_mfma_f32_32x32x16_bf16 v[12:27], v[188:191], v[40:43], v[12:27]
    ds_read_b128 v[36:39], v136 offset:18432
    s_waitcnt lgkmcnt(6)
    s_waitcnt vmcnt(15)
    v_mfma_f32_32x32x16_bf16 v[12:27], v[192:195], v[44:47], v[12:27]
    ds_read_b128 v[40:43], v136 offset:19456
    s_waitcnt lgkmcnt(6)
    s_waitcnt vmcnt(14)
    v_mfma_f32_32x32x16_bf16 v[12:27], v[196:199], v[48:51], v[12:27]
    ds_read_b128 v[44:47], v136 offset:20480
    s_waitcnt lgkmcnt(6)
    s_waitcnt vmcnt(13)
    v_mfma_f32_32x32x16_bf16 v[12:27], v[200:203], v[52:55], v[12:27]
    ds_read_b128 v[48:51], v136 offset:21504
    s_waitcnt lgkmcnt(6)
    s_waitcnt vmcnt(12)
    v_mfma_f32_32x32x16_bf16 v[12:27], v[204:207], v[56:59], v[12:27]
    ds_read_b128 v[52:55], v136 offset:22528
    s_waitcnt lgkmcnt(6)
    s_waitcnt vmcnt(11)
    v_mfma_f32_32x32x16_bf16 v[12:27], v[208:211], v[28:31], v[12:27]
    ds_read_b128 v[56:59], v136 offset:23552
    s_waitcnt lgkmcnt(6)
    s_waitcnt vmcnt(10)
    v_mfma_f32_32x32x16_bf16 v[12:27], v[212:215], v[32:35], v[12:27]
    ds_read_b128 v[28:31], v136 offset:24576
    s_waitcnt lgkmcnt(6)
    s_waitcnt vmcnt(9)
    v_mfma_f32_32x32x16_bf16 v[12:27], v[216:219], v[36:39], v[12:27]
    ds_read_b128 v[32:35], v136 offset:25600
    s_waitcnt lgkmcnt(6)
    s_waitcnt vmcnt(8)
    v_mfma_f32_32x32x16_bf16 v[12:27], v[220:223], v[40:43], v[12:27]
    ds_read_b128 v[36:39], v136 offset:26624
    s_waitcnt lgkmcnt(6)
    s_waitcnt vmcnt(7)
    v_mfma_f32_32x32x16_bf16 v[12:27], v[224:227], v[44:47], v[12:27]
    ds_read_b128 v[40:43], v136 offset:27648
    s_waitcnt lgkmcnt(6)
    s_waitcnt vmcnt(6)
    v_mfma_f32_32x32x16_bf16 v[12:27], v[228:231], v[48:51], v[12:27]
    s_waitcnt lgkmcnt(5)
    s_waitcnt vmcnt(5)
    v_mfma_f32_32x32x16_bf16 v[12:27], v[232:235], v[52:55], v[12:27]
    s_waitcnt lgkmcnt(4)
    s_waitcnt vmcnt(4)
    v_mfma_f32_32x32x16_bf16 v[12:27], v[236:239], v[56:59], v[12:27]
    v_cvt_pk_bf16_f32 v72, -v68, -v68
    v_lshlrev_b32 v60, 16, v72
    v_add_f32 v60, v68, v60
    v_cvt_pk_bf16_f32 v73, -v60, 0
    s_waitcnt lgkmcnt(3)
    s_waitcnt vmcnt(3)
    v_mfma_f32_32x32x16_bf16 v[12:27], v[240:243], v[28:31], v[12:27]
    s_waitcnt lgkmcnt(2)
    s_waitcnt vmcnt(2)
    v_mfma_f32_32x32x16_bf16 v[12:27], v[244:247], v[32:35], v[12:27]
    v_rcp_f32 v60, v69
    s_nop 0
    v_mul_f32 v10, 3222493025, v60
    v_mul_f32 v11, v60, v60
    v_mul_f32 v11, v11, v60
    v_mul_f32 v11, 3184710632, v11
    s_waitcnt lgkmcnt(1)
    s_waitcnt vmcnt(1)
    v_mfma_f32_32x32x16_bf16 v[12:27], v[248:251], v[36:39], v[12:27]
    s_waitcnt lgkmcnt(0)
    s_waitcnt vmcnt(0)
    v_mfma_f32_32x32x16_bf16 v[12:27], v[252:255], v[40:43], v[12:27]
    s_mov_b32 s70, 20985856
    buffer_load_dword v141, v142, s[4:7], s70 offen sc1
    v_add_f32 v132, v132, v133
    v_cvt_pk_bf16_f32 v60, v132, v132
    v_lshlrev_b32 v61, 16, v60
    v_sub_f32 v61, v132, v61
    v_cvt_pk_bf16_f32 v74, v132, v61
    v_and_b32 v75, 0xffff, v60
    v_mov_b32 v76, 0
    v_mov_b32 v77, 0
m0j_33:
    s_nop 1
    v_mfma_f32_32x32x16_bf16 v[12:27], v[74:77], v[72:75], v[12:27]
    s_setprio 0
    s_nop 10
    v_mul_f32 v60, v12, v12
    v_mul_f32 v61, v13, v13
    v_fma_f32 v60, v60, v11, v10
    v_fma_f32 v61, v61, v11, v10
    v_mul_f32 v60, v12, v60
    v_mul_f32 v61, v13, v61
    v_exp_f32 v60, v60
    v_exp_f32 v61, v61
    v_fma_f32 v60, v60, v69, v69
    v_fma_f32 v61, v61, v69, v69
    v_rcp_f32 v62, v60
    v_rcp_f32 v63, v61
    v_mul_f32 v64, v14, v14
    v_mul_f32 v65, v15, v15
    v_fma_f32 v64, v64, v11, v10
    v_fma_f32 v65, v65, v11, v10
    v_mul_f32 v64, v14, v64
    v_mul_f32 v65, v15, v65
    v_exp_f32 v64, v64
    v_exp_f32 v65, v65
    v_mul_f32 v62, v12, v62
    v_mul_f32 v63, v13, v63
    v_cvt_pk_bf16_f32 v28, v62, v63
    v_fma_f32 v64, v64, v69, v69
    v_fma_f32 v65, v65, v69, v69
    v_rcp_f32 v66, v64
    v_rcp_f32 v67, v65
    v_mul_f32 v60, v16, v16
    v_mul_f32 v61, v17, v17
    v_fma_f32 v60, v60, v11, v10
    v_fma_f32 v61, v61, v11, v10
    v_mul_f32 v60, v16, v60
    v_mul_f32 v61, v17, v61
    v_exp_f32 v60, v60
    v_exp_f32 v61, v61
    v_mul_f32 v66, v14, v66
    v_mul_f32 v67, v15, v67
    v_cvt_pk_bf16_f32 v29, v66, v67
    v_fma_f32 v60, v60, v69, v69
    v_fma_f32 v61, v61, v69, v69
    v_rcp_f32 v62, v60
    v_rcp_f32 v63, v61
    v_mul_f32 v64, v18, v18
    v_mul_f32 v65, v19, v19
    v_fma_f32 v64, v64, v11, v10
    v_fma_f32 v65, v65, v11, v10
    v_mul_f32 v64, v18, v64
    v_mul_f32 v65, v19, v65
    v_exp_f32 v64, v64
    v_exp_f32 v65, v65
    v_mul_f32 v62, v16, v62
    v_mul_f32 v63, v17, v63
    v_cvt_pk_bf16_f32 v30, v62, v63
    v_fma_f32 v64, v64, v69, v69
    v_fma_f32 v65, v65, v69, v69
    v_rcp_f32 v66, v64
    v_rcp_f32 v67, v65
    v_mul_f32 v60, v20, v20
    v_mul_f32 v61, v21, v21
    v_fma_f32 v60, v60, v11, v10
    v_fma_f32 v61, v61, v11, v10
    v_mul_f32 v60, v20, v60
    v_mul_f32 v61, v21, v61
    v_exp_f32 v60, v60
    v_exp_f32 v61, v61
    v_mul_f32 v66, v18, v66
    v_mul_f32 v67, v19, v67
    v_cvt_pk_bf16_f32 v31, v66, v67
    buffer_store_dwordx4 v[28:31], v9, s[4:7], s93 offen offset:0 sc1
    v_fma_f32 v60, v60, v69, v69
    v_fma_f32 v61, v61, v69, v69
    v_rcp_f32 v62, v60
    v_rcp_f32 v63, v61
    v_mul_f32 v64, v22, v22
    v_mul_f32 v65, v23, v23
    v_fma_f32 v64, v64, v11, v10
    v_fma_f32 v65, v65, v11, v10
    v_mul_f32 v64, v22, v64
    v_mul_f32 v65, v23, v65
    v_exp_f32 v64, v64
    v_exp_f32 v65, v65
    v_mul_f32 v62, v20, v62
    v_mul_f32 v63, v21, v63
    v_cvt_pk_bf16_f32 v32, v62, v63
    v_fma_f32 v64, v64, v69, v69
    v_fma_f32 v65, v65, v69, v69
    v_rcp_f32 v66, v64
    v_rcp_f32 v67, v65
    v_mul_f32 v60, v24, v24
    v_mul_f32 v61, v25, v25
    v_fma_f32 v60, v60, v11, v10
    v_fma_f32 v61, v61, v11, v10
    v_mul_f32 v60, v24, v60
    v_mul_f32 v61, v25, v61
    v_exp_f32 v60, v60
    v_exp_f32 v61, v61
    v_mul_f32 v66, v22, v66
    v_mul_f32 v67, v23, v67
    v_cvt_pk_bf16_f32 v33, v66, v67
    v_fma_f32 v60, v60, v69, v69
    v_fma_f32 v61, v61, v69, v69
    v_rcp_f32 v62, v60
    v_rcp_f32 v63, v61
    v_mul_f32 v64, v26, v26
    v_mul_f32 v65, v27, v27
    v_fma_f32 v64, v64, v11, v10
    v_fma_f32 v65, v65, v11, v10
    v_mul_f32 v64, v26, v64
    v_mul_f32 v65, v27, v65
    v_exp_f32 v64, v64
    v_exp_f32 v65, v65
    v_mul_f32 v62, v24, v62
    v_mul_f32 v63, v25, v63
    v_cvt_pk_bf16_f32 v34, v62, v63
    v_fma_f32 v64, v64, v69, v69
    v_fma_f32 v65, v65, v69, v69
    v_rcp_f32 v66, v64
    v_rcp_f32 v67, v65
    v_mul_f32 v66, v26, v66
    v_mul_f32 v67, v27, v67
    v_cvt_pk_bf16_f32 v35, v66, v67
    buffer_store_dwordx4 v[32:35], v9, s[4:7], s93 offen offset:1024 sc1
    s_add_u32 s93, s93, 114688
    ds_read_b128 v[28:31], v136 offset:28672
    ds_read_b128 v[32:35], v136 offset:29696
    ds_read_b128 v[36:39], v136 offset:30720
    ds_read_b128 v[40:43], v136 offset:31744
    ds_read_b128 v[44:47], v136 offset:32768
    ds_read_b128 v[48:51], v136 offset:33792
    ds_read_b128 v[52:55], v136 offset:34816
    s_setprio 1
    s_waitcnt lgkmcnt(6)
    v_mfma_f32_32x32x16_bf16 v[12:27], v[144:147], v[28:31], 0
    ds_read_b128 v[56:59], v136 offset:35840
    s_add_u32 s43, s2, 0
    buffer_load_dwordx4 v[80:83], v9, s[4:7], s43 offen offset:0 sc1
    s_waitcnt lgkmcnt(6)
    v_mfma_f32_32x32x16_bf16 v[12:27], v[148:151], v[32:35], v[12:27]
    ds_read_b128 v[28:31], v136 offset:36864
    s_waitcnt lgkmcnt(6)
    v_mfma_f32_32x32x16_bf16 v[12:27], v[152:155], v[36:39], v[12:27]
    ds_read_b128 v[32:35], v136 offset:37888
    buffer_load_dwordx4 v[84:87], v9, s[4:7], s43 offen offset:1024 sc1
    s_waitcnt lgkmcnt(6)
    v_mfma_f32_32x32x16_bf16 v[12:27], v[156:159], v[40:43], v[12:27]
    ds_read_b128 v[36:39], v136 offset:38912
    s_waitcnt lgkmcnt(6)
    v_mfma_f32_32x32x16_bf16 v[12:27], v[160:163], v[44:47], v[12:27]
    ds_read_b128 v[40:43], v136 offset:39936
    buffer_load_dwordx4 v[88:91], v9, s[4:7], s43 offen offset:2048 sc1
    s_waitcnt lgkmcnt(6)
    v_mfma_f32_32x32x16_bf16 v[12:27], v[164:167], v[48:51], v[12:27]
    ds_read_b128 v[44:47], v136 offset:40960
    s_waitcnt lgkmcnt(6)
    v_mfma_f32_32x32x16_bf16 v[12:27], v[168:171], v[52:55], v[12:27]
    ds_read_b128 v[48:51], v136 offset:41984
    buffer_load_dwordx4 v[92:95], v9, s[4:7], s43 offen offset:3072 sc1
    s_waitcnt lgkmcnt(6)
    v_mfma_f32_32x32x16_bf16 v[12:27], v[172:175], v[56:59], v[12:27]
    ds_read_b128 v[52:55], v136 offset:43008
    s_waitcnt lgkmcnt(6)
    v_mfma_f32_32x32x16_bf16 v[12:27], v[176:179], v[28:31], v[12:27]
    ds_read_b128 v[56:59], v136 offset:44032
    s_add_u32 s43, s2, 4096
    buffer_load_dwordx4 v[96:99], v9, s[4:7], s43 offen offset:0 sc1
    s_waitcnt vmcnt(5)
    s_mov_b64 exec, 0xff
    buffer_store_dwordx4 v[128:131], v9, s[4:7], s46 offen sc1
    s_mov_b64 exec, -1
    s_waitcnt lgkmcnt(6)
    v_mfma_f32_32x32x16_bf16 v[12:27], v[180:183], v[32:35], v[12:27]
    ds_read_b128 v[28:31], v136 offset:45056
    s_waitcnt lgkmcnt(6)
    v_mfma_f32_32x32x16_bf16 v[12:27], v[184:187], v[36:39], v[12:27]
    ds_read_b128 v[32:35], v136 offset:46080
    buffer_load_dwordx4 v[100:103], v9, s[4:7], s43 offen offset:1024 sc1
    s_waitcnt lgkmcnt(6)
    v_mfma_f32_32x32x16_bf16 v[12:27], v[188:191], v[40:43], v[12:27]
    ds_read_b128 v[36:39], v136 offset:47104
    s_waitcnt lgkmcnt(6)
    v_mfma_f32_32x32x16_bf16 v[12:27], v[192:195], v[44:47], v[12:27]
    ds_read_b128 v[40:43], v136 offset:48128
    buffer_load_dwordx4 v[104:107], v9, s[4:7], s43 offen offset:2048 sc1
    s_waitcnt lgkmcnt(6)
    v_mfma_f32_32x32x16_bf16 v[12:27], v[196:199], v[48:51], v[12:27]
    ds_read_b128 v[44:47], v136 offset:49152
    s_waitcnt lgkmcnt(6)
    v_mfma_f32_32x32x16_bf16 v[12:27], v[200:203], v[52:55], v[12:27]
    ds_read_b128 v[48:51], v136 offset:50176
    buffer_load_dwordx4 v[108:111], v9, s[4:7], s43 offen offset:3072 sc1
    s_waitcnt lgkmcnt(6)
    v_mfma_f32_32x32x16_bf16 v[12:27], v[204:207], v[56:59], v[12:27]
    ds_read_b128 v[52:55], v136 offset:51200
    s_waitcnt lgkmcnt(6)
    v_mfma_f32_32x32x16_bf16 v[12:27], v[208:211], v[28:31], v[12:27]
    ds_read_b128 v[56:59], v136 offset:52224
    s_add_u32 s43, s2, 8192
    buffer_load_dwordx4 v[112:115], v9, s[4:7], s43 offen offset:0 sc1
    s_waitcnt lgkmcnt(6)
    v_mfma_f32_32x32x16_bf16 v[12:27], v[212:215], v[32:35], v[12:27]
    ds_read_b128 v[28:31], v136 offset:53248
    s_waitcnt lgkmcnt(6)
    v_mfma_f32_32x32x16_bf16 v[12:27], v[216:219], v[36:39], v[12:27]
    ds_read_b128 v[32:35], v136 offset:54272
    buffer_load_dwordx4 v[116:119], v9, s[4:7], s43 offen offset:1024 sc1
    s_waitcnt lgkmcnt(6)
    v_mfma_f32_32x32x16_bf16 v[12:27], v[220:223], v[40:43], v[12:27]
    ds_read_b128 v[36:39], v136 offset:55296
    s_waitcnt lgkmcnt(6)
    v_mfma_f32_32x32x16_bf16 v[12:27], v[224:227], v[44:47], v[12:27]
    ds_read_b128 v[40:43], v136 offset:56320
    buffer_load_dwordx4 v[120:123], v9, s[4:7], s43 offen offset:2048 sc1
    v_lshlrev_b32 v7, 7, v1
    s_add_u32 s100, s45, 17301504
    s_waitcnt lgkmcnt(6)
    v_mfma_f32_32x32x16_bf16 v[12:27], v[228:231], v[48:51], v[12:27]
    s_waitcnt lgkmcnt(5)
    v_mfma_f32_32x32x16_bf16 v[12:27], v[232:235], v[52:55], v[12:27]
    buffer_load_dwordx4 v[124:127], v9, s[4:7], s43 offen offset:3072 sc1
    s_waitcnt lgkmcnt(4)
    v_mfma_f32_32x32x16_bf16 v[12:27], v[236:239], v[56:59], v[12:27]
    v_cvt_pk_bf16_f32 v72, -v70, -v70
    v_lshlrev_b32 v60, 16, v72
    v_add_f32 v60, v70, v60
    v_cvt_pk_bf16_f32 v73, -v60, 0
    s_waitcnt lgkmcnt(3)
    v_mfma_f32_32x32x16_bf16 v[12:27], v[240:243], v[28:31], v[12:27]
    s_waitcnt lgkmcnt(2)
    v_mfma_f32_32x32x16_bf16 v[12:27], v[244:247], v[32:35], v[12:27]
    v_rcp_f32 v60, v71
    s_nop 0
    v_mul_f32 v10, 3222493025, v60
    v_mul_f32 v11, v60, v60
    v_mul_f32 v11, v11, v60
    v_mul_f32 v11, 3184710632, v11
    s_waitcnt lgkmcnt(1)
    v_mfma_f32_32x32x16_bf16 v[12:27], v[248:251], v[36:39], v[12:27]
    s_waitcnt lgkmcnt(0)
    v_mfma_f32_32x32x16_bf16 v[12:27], v[252:255], v[40:43], v[12:27]
    v_mfma_f32_32x32x16_bf16 v[12:27], v[74:77], v[72:75], v[12:27]
    s_setprio 0
    v_mov_b32 v136, v7
    s_nop 9
    v_mul_f32 v60, v12, v12
    v_mul_f32 v61, v13, v13
    v_fma_f32 v60, v60, v11, v10
    v_fma_f32 v61, v61, v11, v10
    v_mul_f32 v60, v12, v60
    v_mul_f32 v61, v13, v61
    v_exp_f32 v60, v60
    v_exp_f32 v61, v61
    v_fma_f32 v60, v60, v71, v71
    v_fma_f32 v61, v61, v71, v71
    v_rcp_f32 v62, v60
    v_rcp_f32 v63, v61
    v_mul_f32 v64, v14, v14
    v_mul_f32 v65, v15, v15
    v_fma_f32 v64, v64, v11, v10
    v_fma_f32 v65, v65, v11, v10
    v_mul_f32 v64, v14, v64
    v_mul_f32 v65, v15, v65
    v_exp_f32 v64, v64
    v_exp_f32 v65, v65
    v_mul_f32 v62, v12, v62
    v_mul_f32 v63, v13, v63
    v_cvt_pk_bf16_f32 v28, v62, v63
    s_add_u32 s43, s2, 12288
    buffer_load_dwordx4 v[144:147], v9, s[4:7], s43 offen offset:0 sc1
    v_fma_f32 v64, v64, v71, v71
    v_fma_f32 v65, v65, v71, v71
    v_rcp_f32 v66, v64
    v_rcp_f32 v67, v65
    v_mul_f32 v60, v16, v16
    v_mul_f32 v61, v17, v17
    v_fma_f32 v60, v60, v11, v10
    v_fma_f32 v61, v61, v11, v10
    v_mul_f32 v60, v16, v60
    v_mul_f32 v61, v17, v61
    v_exp_f32 v60, v60
    v_exp_f32 v61, v61
    v_mul_f32 v66, v14, v66
    v_mul_f32 v67, v15, v67
    v_cvt_pk_bf16_f32 v29, v66, v67
    buffer_load_dwordx4 v[148:151], v9, s[4:7], s43 offen offset:1024 sc1
    v_fma_f32 v60, v60, v71, v71
    v_fma_f32 v61, v61, v71, v71
    v_rcp_f32 v62, v60
    v_rcp_f32 v63, v61
    v_mul_f32 v64, v18, v18
    v_mul_f32 v65, v19, v19
    v_fma_f32 v64, v64, v11, v10
    v_fma_f32 v65, v65, v11, v10
    v_mul_f32 v64, v18, v64
    v_mul_f32 v65, v19, v65
    v_exp_f32 v64, v64
    v_exp_f32 v65, v65
    v_mul_f32 v62, v16, v62
    v_mul_f32 v63, v17, v63
    v_cvt_pk_bf16_f32 v30, v62, v63
    buffer_load_dwordx4 v[152:155], v9, s[4:7], s43 offen offset:2048 sc1
    v_fma_f32 v64, v64, v71, v71
    v_fma_f32 v65, v65, v71, v71
    v_rcp_f32 v66, v64
    v_rcp_f32 v67, v65
    v_mul_f32 v60, v20, v20
    v_mul_f32 v61, v21, v21
    v_fma_f32 v60, v60, v11, v10
    v_fma_f32 v61, v61, v11, v10
    v_mul_f32 v60, v20, v60
    v_mul_f32 v61, v21, v61
    v_exp_f32 v60, v60
    v_exp_f32 v61, v61
    v_mul_f32 v66, v18, v66
    v_mul_f32 v67, v19, v67
    v_cvt_pk_bf16_f32 v31, v66, v67
    buffer_store_dwordx4 v[28:31], v9, s[4:7], s93 offen offset:0 sc1
    buffer_load_dwordx4 v[156:159], v9, s[4:7], s43 offen offset:3072 sc1
    v_fma_f32 v60, v60, v71, v71
    v_fma_f32 v61, v61, v71, v71
    v_rcp_f32 v62, v60
    v_rcp_f32 v63, v61
    v_mul_f32 v64, v22, v22
    v_mul_f32 v65, v23, v23
    v_fma_f32 v64, v64, v11, v10
    v_fma_f32 v65, v65, v11, v10
    v_mul_f32 v64, v22, v64
    v_mul_f32 v65, v23, v65
    v_exp_f32 v64, v64
    v_exp_f32 v65, v65
    v_mul_f32 v62, v20, v62
    v_mul_f32 v63, v21, v63
    v_cvt_pk_bf16_f32 v32, v62, v63
    s_add_u32 s43, s2, 16384
    buffer_load_dwordx4 v[160:163], v9, s[4:7], s43 offen offset:0 sc1
    v_fma_f32 v64, v64, v71, v71
    v_fma_f32 v65, v65, v71, v71
    v_rcp_f32 v66, v64
    v_rcp_f32 v67, v65
    v_mul_f32 v60, v24, v24
    v_mul_f32 v61, v25, v25
    v_fma_f32 v60, v60, v11, v10
    v_fma_f32 v61, v61, v11, v10
    v_mul_f32 v60, v24, v60
    v_mul_f32 v61, v25, v61
    v_exp_f32 v60, v60
    v_exp_f32 v61, v61
    v_mul_f32 v66, v22, v66
    v_mul_f32 v67, v23, v67
    v_cvt_pk_bf16_f32 v33, v66, v67
    buffer_load_dwordx4 v[164:167], v9, s[4:7], s43 offen offset:1024 sc1
    v_fma_f32 v60, v60, v71, v71
    v_fma_f32 v61, v61, v71, v71
    v_rcp_f32 v62, v60
    v_rcp_f32 v63, v61
    v_mul_f32 v64, v26, v26
    v_mul_f32 v65, v27, v27
    v_fma_f32 v64, v64, v11, v10
    v_fma_f32 v65, v65, v11, v10
    v_mul_f32 v64, v26, v64
    v_mul_f32 v65, v27, v65
    v_exp_f32 v64, v64
    v_exp_f32 v65, v65
    v_mul_f32 v62, v24, v62
    v_mul_f32 v63, v25, v63
    v_cvt_pk_bf16_f32 v34, v62, v63
    buffer_load_dwordx4 v[168:171], v9, s[4:7], s43 offen offset:2048 sc1
    v_fma_f32 v64, v64, v71, v71
    v_fma_f32 v65, v65, v71, v71
    v_rcp_f32 v66, v64
    v_rcp_f32 v67, v65
    v_mul_f32 v66, v26, v66
    v_mul_f32 v67, v27, v67
    v_cvt_pk_bf16_f32 v35, v66, v67
    buffer_store_dwordx4 v[32:35], v9, s[4:7], s93 offen offset:1024 sc1
    v_mov_b32 v6, 163400
    v_mov_b32 v5, 1
    s_mov_b64 exec, 1
    ds_add_u32 v6, v5
    s_mov_b64 exec, -1
    buffer_load_dwordx4 v[172:175], v9, s[4:7], s43 offen offset:3072 sc1
    s_add_u32 s43, s2, 20480
    buffer_load_dwordx4 v[176:179], v9, s[4:7], s43 offen offset:0 sc1
    buffer_load_dwordx4 v[180:183], v9, s[4:7], s43 offen offset:1024 sc1
    buffer_load_dwordx4 v[184:187], v9, s[4:7], s43 offen offset:2048 sc1
    buffer_load_dwordx4 v[188:191], v9, s[4:7], s43 offen offset:3072 sc1
    s_add_u32 s43, s2, 24576
    buffer_load_dwordx4 v[192:195], v9, s[4:7], s43 offen offset:0 sc1
    buffer_load_dwordx4 v[196:199], v9, s[4:7], s43 offen offset:1024 sc1
    buffer_load_dwordx4 v[200:203], v9, s[4:7], s43 offen offset:2048 sc1
    buffer_load_dwordx4 v[204:207], v9, s[4:7], s43 offen offset:3072 sc1
    s_cmp_lt_u32 s51, 4
    s_cbranch_scc1 c1_34
    s_waitcnt vmcnt(9)
    s_mov_b64 exec, 0xff
    buffer_store_dwordx4 v[128:131], v9, s[4:7], s47 offen sc1
    s_mov_b64 exec, -1
    s_branch c2_35
c1_34:
    s_lshr_b32 s24, s51, 1
    s_and_b32 s23, s51, 1
    s_lshl_b32 s21, s64, 1
    s_add_u32 s21, s21, s24
    s_mul_i32 s20, s24, 5280
    s_add_u32 s20, s20, 148032
    s_lshl_b32 s22, s24, 2
    s_add_u32 s22, s22, 163340
    s_lshl_b32 s70, s64, 2
    s_add_u32 s70, s70, s51
    s_lshl_b32 s70, s70, 7
    s_add_u32 s41, s70, 17170432
    v_and_b32 v5, 3, v1
    v_mul_u32_u24 v137, 4160, v5
    v_and_b32 v6, 48, v1
    v_add_u32 v137, v137, v6
    v_bfe_u32 v5, v1, 2, 2
    v_lshlrev_b32 v5, 3, v5
    v_sub_u32 v137, v137, v5
    s_mul_i32 s70, s24, 16640
    s_lshl_b32 s71, s23, 10
    s_sub_u32 s70, s70, s71
    s_add_u32 s70, s70, 117880
    v_add_u32 v137, s70, v137
    v_and_b32 v5, 15, v1
    v_mul_u32_u24 v5, 160, v5
    s_mul_i32 s70, s23, 1280
    s_sub_u32 s70, s20, s70
    s_add_u32 s70, s70, 1440
    v_add3_u32 v138, v5, v6, s70
    v_and_b32 v5, 32, v1
    v_add_u32 v139, v138, v5
    s_mul_i32 s70, s24, 20480
    s_add_u32 s70, s70, 4096
    v_add_u32 v71, s70, v9
    s_lshl_b32 s70, s51, 12
    s_add_u32 s70, s70, 40960
    v_add_u32 v76, s70, v9
    s_waitcnt lgkmcnt(0)
    v_mov_b32 v6, 163452
    s_mov_b32 s70, 0
ls_36:
    ds_read_b32 v5, v6
    s_add_u32 s70, s70, 1
    s_waitcnt lgkmcnt(0)
    v_readfirstlane_b32 s71, v5
    s_nop 0
    s_cmp_ge_u32 s71, 4
    s_nop 1
    s_cbranch_scc1 lsd_37
    s_cmp_lt_u32 s70, 3200000
    s_cbranch_scc1 ls_36
lsd_37:
    ds_read_b128 v[28:31], v76 offset:0
    ds_read_b128 v[32:35], v76 offset:1024
    ds_read_b128 v[36:39], v76 offset:2048
    ds_read_b128 v[40:43], v76 offset:3072
    ds_read_b128 v[236:239], v139 offset:1376
    ds_read_b128 v[232:235], v138 offset:1344
    ds_read_b128 v[228:231], v138 offset:1312
    ds_read_b128 v[224:227], v138 offset:1280
    ds_read_b64 v[208:209], v137 offset:960
    ds_read_b64 v[210:211], v137 offset:968
    ds_read_b128 v[252:255], v139 offset:1216
    ds_read_b128 v[248:251], v138 offset:1184
    ds_read_b64 v[212:213], v137 offset:896
    ds_read_b64 v[214:215], v137 offset:904
    s_waitcnt lgkmcnt(4)
    v_mfma_f32_16x16x32_bf16 v[24:27], v[208:211], v[236:239], 0
    ds_read_b128 v[244:247], v138 offset:1152
    v_mfma_f32_16x16x32_bf16 v[20:23], v[208:211], v[232:235], 0
    ds_read_b128 v[240:243], v138 offset:1120
    v_mfma_f32_16x16x32_bf16 v[16:19], v[208:211], v[228:231], 0
    ds_read_b64 v[216:217], v137 offset:832
    v_mfma_f32_16x16x32_bf16 v[12:15], v[208:211], v[224:227], 0
    ds_read_b64 v[218:219], v137 offset:840
    s_waitcnt lgkmcnt(4)
    v_mfma_f32_16x16x32_bf16 v[24:27], v[212:215], v[228:231], v[24:27]
    ds_read_b128 v[236:239], v139 offset:1056
    v_mfma_f32_16x16x32_bf16 v[20:23], v[212:215], v[224:227], v[20:23]
    ds_read_b128 v[232:235], v138 offset:1024
    v_mfma_f32_16x16x32_bf16 v[16:19], v[212:215], v[252:255], v[16:19]
    ds_read_b64 v[220:221], v137 offset:768
    v_mfma_f32_16x16x32_bf16 v[12:15], v[212:215], v[248:251], v[12:15]
    ds_read_b64 v[222:223], v137 offset:776
    s_waitcnt lgkmcnt(4)
    v_mfma_f32_16x16x32_bf16 v[24:27], v[216:219], v[252:255], v[24:27]
    ds_read_b128 v[228:231], v138 offset:992
    v_mfma_f32_16x16x32_bf16 v[20:23], v[216:219], v[248:251], v[20:23]
    ds_read_b128 v[224:227], v138 offset:960
    v_mfma_f32_16x16x32_bf16 v[16:19], v[216:219], v[244:247], v[16:19]
    ds_read_b64 v[208:209], v137 offset:704
    v_mfma_f32_16x16x32_bf16 v[12:15], v[216:219], v[240:243], v[12:15]
    ds_read_b64 v[210:211], v137 offset:712
    s_waitcnt lgkmcnt(4)
    v_mfma_f32_16x16x32_bf16 v[24:27], v[220:223], v[244:247], v[24:27]
    ds_read_b128 v[252:255], v139 offset:896
    v_mfma_f32_16x16x32_bf16 v[20:23], v[220:223], v[240:243], v[20:23]
    ds_read_b128 v[248:251], v138 offset:864
    v_mfma_f32_16x16x32_bf16 v[16:19], v[220:223], v[236:239], v[16:19]
    ds_read_b64 v[212:213], v137 offset:640
    v_mfma_f32_16x16x32_bf16 v[12:15], v[220:223], v[232:235], v[12:15]
    ds_read_b64 v[214:215], v137 offset:648
    s_waitcnt vmcnt(9)
    s_mov_b64 exec, 0xff
    buffer_store_dwordx4 v[128:131], v9, s[4:7], s47 offen sc1
    s_mov_b64 exec, -1
    s_waitcnt lgkmcnt(4)
    v_mfma_f32_16x16x32_bf16 v[24:27], v[208:211], v[236:239], v[24:27]
    ds_read_b128 v[244:247], v138 offset:832
    v_mfma_f32_16x16x32_bf16 v[20:23], v[208:211], v[232:235], v[20:23]
    ds_read_b128 v[240:243], v138 offset:800
    v_mfma_f32_16x16x32_bf16 v[16:19], v[208:211], v[228:231], v[16:19]
    ds_read_b64 v[216:217], v137 offset:576
    v_mfma_f32_16x16x32_bf16 v[12:15], v[208:211], v[224:227], v[12:15]
    ds_read_b64 v[218:219], v137 offset:584
    s_waitcnt lgkmcnt(4)
    v_mfma_f32_16x16x32_bf16 v[24:27], v[212:215], v[228:231], v[24:27]
    ds_read_b128 v[236:239], v139 offset:736
    v_mfma_f32_16x16x32_bf16 v[20:23], v[212:215], v[224:227], v[20:23]
    ds_read_b128 v[232:235], v138 offset:704
    v_mfma_f32_16x16x32_bf16 v[16:19], v[212:215], v[252:255], v[16:19]
    ds_read_b64 v[220:221], v137 offset:512
    v_mfma_f32_16x16x32_bf16 v[12:15], v[212:215], v[248:251], v[12:15]
    ds_read_b64 v[222:223], v137 offset:520
    s_waitcnt lgkmcnt(4)
    v_mfma_f32_16x16x32_bf16 v[24:27], v[216:219], v[252:255], v[24:27]
    ds_read_b128 v[228:231], v138 offset:672
    v_mfma_f32_16x16x32_bf16 v[20:23], v[216:219], v[248:251], v[20:23]
    ds_read_b128 v[224:227], v138 offset:640
    v_mfma_f32_16x16x32_bf16 v[16:19], v[216:219], v[244:247], v[16:19]
    ds_read_b64 v[208:209], v137 offset:448
    v_mfma_f32_16x16x32_bf16 v[12:15], v[216:219], v[240:243], v[12:15]
    ds_read_b64 v[210:211], v137 offset:456
    s_waitcnt lgkmcnt(4)
    v_mfma_f32_16x16x32_bf16 v[24:27], v[220:223], v[244:247], v[24:27]
    ds_read_b128 v[252:255], v139 offset:576
    v_mfma_f32_16x16x32_bf16 v[20:23], v[220:223], v[240:243], v[20:23]
    ds_read_b128 v[248:251], v138 offset:544
    v_mfma_f32_16x16x32_bf16 v[16:19], v[220:223], v[236:239], v[16:19]
    ds_read_b64 v[212:213], v137 offset:384
    v_mfma_f32_16x16x32_bf16 v[12:15], v[220:223], v[232:235], v[12:15]
    ds_read_b64 v[214:215], v137 offset:392
    s_waitcnt lgkmcnt(4)
    v_mfma_f32_16x16x32_bf16 v[24:27], v[208:211], v[236:239], v[24:27]
    ds_read_b128 v[244:247], v138 offset:512
    v_mfma_f32_16x16x32_bf16 v[20:23], v[208:211], v[232:235], v[20:23]
    ds_read_b128 v[240:243], v138 offset:480
    v_mfma_f32_16x16x32_bf16 v[16:19], v[208:211], v[228:231], v[16:19]
    ds_read_b64 v[216:217], v137 offset:320
    v_mfma_f32_16x16x32_bf16 v[12:15], v[208:211], v[224:227], v[12:15]
    ds_read_b64 v[218:219], v137 offset:328
    s_waitcnt lgkmcnt(4)
    v_mfma_f32_16x16x32_bf16 v[24:27], v[212:215], v[228:231], v[24:27]
    ds_read_b128 v[236:239], v139 offset:416
    v_mfma_f32_16x16x32_bf16 v[20:23], v[212:215], v[224:227], v[20:23]
    ds_read_b128 v[232:235], v138 offset:384
    v_mfma_f32_16x16x32_bf16 v[16:19], v[212:215], v[252:255], v[16:19]
    ds_read_b64 v[220:221], v137 offset:256
    v_mfma_f32_16x16x32_bf16 v[12:15], v[212:215], v[248:251], v[12:15]
    ds_read_b64 v[222:223], v137 offset:264
    s_waitcnt lgkmcnt(4)
    v_mfma_f32_16x16x32_bf16 v[24:27], v[216:219], v[252:255], v[24:27]
    ds_read_b128 v[228:231], v138 offset:352
    v_mfma_f32_16x16x32_bf16 v[20:23], v[216:219], v[248:251], v[20:23]
    ds_read_b128 v[224:227], v138 offset:320
    v_mfma_f32_16x16x32_bf16 v[16:19], v[216:219], v[244:247], v[16:19]
    ds_read_b64 v[208:209], v137 offset:192
    v_mfma_f32_16x16x32_bf16 v[12:15], v[216:219], v[240:243], v[12:15]
    ds_read_b64 v[210:211], v137 offset:200
    s_waitcnt lgkmcnt(4)
    v_mfma_f32_16x16x32_bf16 v[24:27], v[220:223], v[244:247], v[24:27]
    ds_read_b128 v[252:255], v139 offset:256
    v_mfma_f32_16x16x32_bf16 v[20:23], v[220:223], v[240:243], v[20:23]
    ds_read_b128 v[248:251], v138 offset:224
    v_mfma_f32_16x16x32_bf16 v[16:19], v[220:223], v[236:239], v[16:19]
    ds_read_b64 v[212:213], v137 offset:128
    v_mfma_f32_16x16x32_bf16 v[12:15], v[220:223], v[232:235], v[12:15]
    ds_read_b64 v[214:215], v137 offset:136
    s_waitcnt lgkmcnt(4)
    v_mfma_f32_16x16x32_bf16 v[24:27], v[208:211], v[236:239], v[24:27]
    ds_read_b128 v[244:247], v138 offset:192
    v_mfma_f32_16x16x32_bf16 v[20:23], v[208:211], v[232:235], v[20:23]
    ds_read_b128 v[240:243], v138 offset:160
    v_mfma_f32_16x16x32_bf16 v[16:19], v[208:211], v[228:231], v[16:19]
    ds_read_b64 v[216:217], v137 offset:64
    v_mfma_f32_16x16x32_bf16 v[12:15], v[208:211], v[224:227], v[12:15]
    ds_read_b64 v[218:219], v137 offset:72
    s_waitcnt lgkmcnt(4)
    v_mfma_f32_16x16x32_bf16 v[24:27], v[212:215], v[228:231], v[24:27]
    ds_read_b128 v[236:239], v139 offset:96
    v_mfma_f32_16x16x32_bf16 v[20:23], v[212:215], v[224:227], v[20:23]
    ds_read_b128 v[232:235], v138 offset:64
    v_mfma_f32_16x16x32_bf16 v[16:19], v[212:215], v[252:255], v[16:19]
    ds_read_b64 v[220:221], v137 offset:0
    v_mfma_f32_16x16x32_bf16 v[12:15], v[212:215], v[248:251], v[12:15]
    ds_read_b64 v[222:223], v137 offset:8
    s_waitcnt lgkmcnt(4)
    v_mfma_f32_16x16x32_bf16 v[24:27], v[216:219], v[252:255], v[24:27]
    v_mfma_f32_16x16x32_bf16 v[20:23], v[216:219], v[248:251], v[20:23]
    v_mfma_f32_16x16x32_bf16 v[16:19], v[216:219], v[244:247], v[16:19]
    v_mfma_f32_16x16x32_bf16 v[12:15], v[216:219], v[240:243], v[12:15]
    s_waitcnt lgkmcnt(0)
    v_mfma_f32_16x16x32_bf16 v[24:27], v[220:223], v[244:247], v[24:27]
    v_mfma_f32_16x16x32_bf16 v[20:23], v[220:223], v[240:243], v[20:23]
    v_mfma_f32_16x16x32_bf16 v[16:19], v[220:223], v[236:239], v[16:19]
    v_mfma_f32_16x16x32_bf16 v[12:15], v[220:223], v[232:235], v[12:15]
    s_cmp_eq_u32 s23, 1
    s_nop 5
    s_cbranch_scc1 sa_38
    ds_write_b128 v71, v[12:15] offset:0
    ds_write_b128 v71, v[16:19] offset:1024
    ds_write_b128 v71, v[20:23] offset:2048
    ds_write_b128 v71, v[24:27] offset:3072
    s_add_u32 s70, s22, 8
    v_mov_b32 v6, s70
    v_mov_b32 v5, 1
    s_mov_b64 exec, 1
    ds_add_u32 v6, v5
    s_mov_b64 exec, -1
sa_38:
    v_lshrrev_b32 v7, 4, v1
    v_and_b32 v5, 15, v1
    v_mul_u32_u24 v69, 160, v5
    v_lshl_add_u32 v69, v7, 3, v69
    s_mul_i32 s70, s23, 2560
    s_add_u32 s70, s70, s20
    v_add_u32 v69, s70, v69
    v_mul_u32_u24 v70, 144, v5
    v_lshl_add_u32 v70, v7, 3, v70
    s_mov_b32 s70, s99
    v_add_u32 v70, s70, v70
    v_lshrrev_b32 v5, 3, v1
    v_mul_u32_u24 v76, 144, v5
    v_and_b32 v7, 7, v1
    v_lshl_add_u32 v76, v7, 4, v76
    v_add_u32 v76, s70, v76
    s_lshl_b32 s25, s35, 16
    s_and_b32 s71, s35, 0xffff0000
    s_cmp_eq_u32 s24, 1
    s_cselect_b32 s25, s71, s25
    s_lshl_b32 s70, s21, 12
    s_lshl_b32 s71, s23, 11
    s_add_u32 s70, s70, s71
    s_add_u32 s26, s70, 14680064
    ds_read_b64 v[224:225], v69 offset:160
    ds_read_b64 v[226:227], v69 offset:192
    ds_read_b64 v[228:229], v69 offset:224
    ds_read_b64 v[230:231], v69 offset:256
    s_cmp_eq_u32 s23, 0
    s_cbranch_scc1 ry_39
    s_add_u32 s22, s22, 8
    s_waitcnt lgkmcnt(0)
    v_mov_b32 v6, s22
    s_mov_b32 s70, 0
ls_40:
    ds_read_b32 v5, v6
    s_add_u32 s70, s70, 1
    s_waitcnt lgkmcnt(0)
    v_readfirstlane_b32 s71, v5
    s_nop 0
    s_cmp_ge_u32 s71, 1
    s_nop 1
    s_cbranch_scc1 lsd_41
    s_cmp_lt_u32 s70, 3200000
    s_cbranch_scc1 ls_40
lsd_41:
    ds_read_b128 v[240:243], v71 offset:0
    ds_read_b128 v[244:247], v71 offset:1024
    ds_read_b128 v[248:251], v71 offset:2048
    ds_read_b128 v[252:255], v71 offset:3072
    v_add_f32 v28, v28, v12
    v_add_f32 v29, v29, v13
    v_add_f32 v30, v30, v14
    v_add_f32 v31, v31, v15
    v_add_f32 v32, v32, v16
    v_add_f32 v33, v33, v17
    v_add_f32 v34, v34, v18
    v_add_f32 v35, v35, v19
    v_add_f32 v36, v36, v20
    v_add_f32 v37, v37, v21
    v_add_f32 v38, v38, v22
    v_add_f32 v39, v39, v23
    v_add_f32 v40, v40, v24
    v_add_f32 v41, v41, v25
    v_add_f32 v42, v42, v26
    v_add_f32 v43, v43, v27
    s_waitcnt lgkmcnt(0)
    v_add_f32 v28, v28, v240
    v_add_f32 v29, v29, v241
    v_add_f32 v30, v30, v242
    v_add_f32 v31, v31, v243
    v_add_f32 v32, v32, v244
    v_add_f32 v33, v33, v245
    v_add_f32 v34, v34, v246
    v_add_f32 v35, v35, v247
    v_add_f32 v36, v36, v248
    v_add_f32 v37, v37, v249
    v_add_f32 v38, v38, v250
    v_add_f32 v39, v39, v251
    v_add_f32 v40, v40, v252
    v_add_f32 v41, v41, v253
    v_add_f32 v42, v42, v254
    v_add_f32 v43, v43, v255
ry_39:
    s_waitcnt lgkmcnt(3)
    v_lshlrev_b32 v208, 16, v224
    v_and_b32 v209, 0xffff0000, v224
    v_lshlrev_b32 v210, 16, v225
    v_and_b32 v211, 0xffff0000, v225
    v_fma_f32 v208, v208, s25, v28
    v_fma_f32 v209, v209, s25, v29
    v_fma_f32 v210, v210, s25, v30
    v_fma_f32 v211, v211, s25, v31
    v_cvt_pk_bf16_f32 v224, v208, v209
    v_cvt_pk_bf16_f32 v225, v210, v211
    s_waitcnt lgkmcnt(2)
    v_lshlrev_b32 v212, 16, v226
    v_and_b32 v213, 0xffff0000, v226
    v_lshlrev_b32 v214, 16, v227
    v_and_b32 v215, 0xffff0000, v227
    v_fma_f32 v212, v212, s25, v32
    v_fma_f32 v213, v213, s25, v33
    v_fma_f32 v214, v214, s25, v34
    v_fma_f32 v215, v215, s25, v35
    v_cvt_pk_bf16_f32 v226, v212, v213
    v_cvt_pk_bf16_f32 v227, v214, v215
    s_waitcnt lgkmcnt(1)
    v_lshlrev_b32 v216, 16, v228
    v_and_b32 v217, 0xffff0000, v228
    v_lshlrev_b32 v218, 16, v229
    v_and_b32 v219, 0xffff0000, v229
    v_fma_f32 v216, v216, s25, v36
    v_fma_f32 v217, v217, s25, v37
    v_fma_f32 v218, v218, s25, v38
    v_fma_f32 v219, v219, s25, v39
    v_cvt_pk_bf16_f32 v228, v216, v217
    v_cvt_pk_bf16_f32 v229, v218, v219
    s_waitcnt lgkmcnt(0)
    v_lshlrev_b32 v220, 16, v230
    v_and_b32 v221, 0xffff0000, v230
    v_lshlrev_b32 v222, 16, v231
    v_and_b32 v223, 0xffff0000, v231
    v_fma_f32 v220, v220, s25, v40
    v_fma_f32 v221, v221, s25, v41
    v_fma_f32 v222, v222, s25, v42
    v_fma_f32 v223, v223, s25, v43
    v_cvt_pk_bf16_f32 v230, v220, v221
    v_cvt_pk_bf16_f32 v231, v222, v223
    ds_write_b64 v70, v[224:225] offset:0
    ds_write_b64 v70, v[226:227] offset:32
    ds_write_b64 v70, v[228:229] offset:64
    ds_write_b64 v70, v[230:231] offset:96
    ds_read_b128 v[208:211], v76 offset:0
    ds_read_b128 v[212:215], v76 offset:1152
    s_waitcnt lgkmcnt(1)
    buffer_store_dwordx4 v[208:211], v9, s[4:7], s26 offen offset:0 sc1
    s_waitcnt lgkmcnt(0)
    buffer_store_dwordx4 v[212:215], v9, s[4:7], s26 offen offset:1024 sc1
    v_mov_b32 v6, 163392
    v_mov_b32 v5, 1
    s_mov_b64 exec, 1
    ds_add_u32 v6, v5
    s_mov_b64 exec, -1
c2_35:
    s_waitcnt lgkmcnt(0)
    v_mov_b32 v6, 163400
    s_mov_b32 s70, 0
ls_42:
    ds_read_b32 v5, v6
    s_add_u32 s70, s70, 1
    s_waitcnt lgkmcnt(0)
    v_readfirstlane_b32 s71, v5
    s_nop 0
    s_cmp_ge_u32 s71, 8
    s_nop 1
    s_cbranch_scc1 lsd_43
    s_cmp_lt_u32 s70, 3200000
    s_cbranch_scc1 ls_42
lsd_43:
    s_mov_b32 exec_lo, 0x7F
    s_mov_b32 exec_hi, 0
    s_mov_b32 s71, 0
poll_44:
    buffer_load_dword v2, v136, s[4:7], s100 offen sc1
    s_add_u32 s71, s71, 1
    s_waitcnt vmcnt(0)
    v_cmp_ne_u32 vcc, s50, v2
    s_nop 3
    s_cbranch_vccz polld_45
    s_cmp_lt_u32 s71, 400000
    s_cbranch_scc1 poll_44
polld_45:
    s_mov_b64 exec, -1
    s_cmp_ge_u32 s51, 4
    s_cbranch_scc1 sf_47
    s_mov_b64 exec, 0xff
    buffer_store_dwordx4 v[128:131], v9, s[4:7], s41 offen sc1
    s_mov_b64 exec, -1
sf_47:
    s_add_u32 s71, s44, 0
    buffer_load_dwordx4 v[208:211], v9, s[4:7], s71 offen offset:0 sc1
    buffer_load_dwordx4 v[212:215], v9, s[4:7], s71 offen offset:1024 sc1
    buffer_load_dwordx4 v[216:219], v9, s[4:7], s71 offen offset:2048 sc1
    buffer_load_dwordx4 v[220:223], v9, s[4:7], s71 offen offset:3072 sc1
    s_add_u32 s71, s44, 4096
    buffer_load_dwordx4 v[224:227], v9, s[4:7], s71 offen offset:0 sc1
    buffer_load_dwordx4 v[228:231], v9, s[4:7], s71 offen offset:1024 sc1
    buffer_load_dwordx4 v[232:235], v9, s[4:7], s71 offen offset:2048 sc1
    buffer_load_dwordx4 v[236:239], v9, s[4:7], s71 offen offset:3072 sc1
    s_add_u32 s71, s44, 8192
    buffer_load_dwordx4 v[240:243], v9, s[4:7], s71 offen offset:0 sc1
    buffer_load_dwordx4 v[244:247], v9, s[4:7], s71 offen offset:1024 sc1
    buffer_load_dwordx4 v[248:251], v9, s[4:7], s71 offen offset:2048 sc1
    buffer_load_dwordx4 v[252:255], v9, s[4:7], s71 offen offset:3072 sc1
    s_add_u32 s71, s44, 12288
    buffer_load_dwordx4 v[44:47], v9, s[4:7], s71 offen offset:0 sc1
    buffer_load_dwordx4 v[48:51], v9, s[4:7], s71 offen offset:1024 sc1
    s_add_u32 s44, s44, 114688
    v_lshrrev_b32 v5, 4, v1
    s_lshl_b32 s70, s51, 2
    v_add_u32 v5, s70, v5
    v_bfe_u32 v6, v1, 1, 3
    v_and_b32 v7, 7, v5
    v_xor_b32 v11, v6, v7
    v_lshlrev_b32 v11, 4, v11
    v_lshl_add_u32 v11, v5, 7, v11
    v_and_b32 v10, 1, v1
    v_lshl_add_u32 v11, v10, 3, v11
    v_and_b32 v64, 6, v6
    v_add_u32 v64, v64, v10
    v_lshlrev_b32 v72, 4, v64
    v_xor_b32 v64, v64, v7
    v_lshlrev_b32 v64, 4, v64
    v_lshl_add_u32 v64, v5, 7, v64
    v_bfe_u32 v7, v1, 1, 1
    v_lshl_add_u32 v64, v7, 3, v64
    v_add_u32 v64, 147456, v64
    v_lshl_add_u32 v72, v7, 3, v72
    v_lshlrev_b32 v73, 9, v7
    v_lshl_add_u32 v73, v5, 4, v73
    v_lshl_add_u32 v73, v10, 3, v73
    v_lshrrev_b32 v6, 1, v6
    v_lshl_add_u32 v73, v6, 10, v73
    s_lshl_b32 s70, s65, 12
    s_add_u32 s70, s70, 57344
    v_add_u32 v73, s70, v73
    v_mul_u32_u24 v10, 896, v5
    v_add_u32 v10, v10, v72
    s_mul_i32 s48, s67, 896
    s_add_u32 s48, s48, s49
    ds_read_b64 v[52:53], v73 offset:0
    ds_read_b64 v[54:55], v73 offset:28672
    s_add_u32 s70, s48, 28672
    buffer_load_dwordx2 v[56:57], v10, s[52:55], s48 offen
    buffer_load_dwordx2 v[58:59], v10, s[52:55], s70 offen
    s_waitcnt vmcnt(15)
    v_mfma_f32_32x32x16_bf16 v[12:27], v[80:83], v[208:211], 0
    v_and_b32 v5, 31, v1
    v_and_b32 v6, 7, v1
    v_mfma_f32_32x32x16_bf16 v[28:43], v[84:87], v[208:211], 0
    v_lshrrev_b32 v7, 5, v1
    v_xor_b32 v6, v6, v7
    s_waitcnt vmcnt(14)
    v_mfma_f32_32x32x16_bf16 v[12:27], v[88:91], v[212:215], v[12:27]
    v_lshlrev_b32 v5, 7, v5
    v_xor_b32 v65, 0, v6
    v_mfma_f32_32x32x16_bf16 v[28:43], v[92:95], v[212:215], v[28:43]
    v_lshl_add_u32 v65, v65, 4, v5
    v_xor_b32 v66, 2, v6
    s_waitcnt vmcnt(13)
    v_mfma_f32_32x32x16_bf16 v[12:27], v[96:99], v[216:219], v[12:27]
    v_lshl_add_u32 v66, v66, 4, v5
    v_xor_b32 v67, 4, v6
    v_mfma_f32_32x32x16_bf16 v[28:43], v[100:103], v[216:219], v[28:43]
    v_lshl_add_u32 v67, v67, 4, v5
    v_xor_b32 v68, 6, v6
    s_waitcnt vmcnt(12)
    v_mfma_f32_32x32x16_bf16 v[12:27], v[104:107], v[220:223], v[12:27]
    v_lshl_add_u32 v68, v68, 4, v5
    s_mov_b32 s70, s99
    v_mfma_f32_32x32x16_bf16 v[28:43], v[108:111], v[220:223], v[28:43]
    v_add_u32 v135, s70, v9
    v_bfe_u32 v134, v1, 2, 2
    s_waitcnt vmcnt(11)
    v_mfma_f32_32x32x16_bf16 v[12:27], v[112:115], v[224:227], v[12:27]
    v_lshlrev_b32 v134, 7, v134
    v_lshrrev_b32 v6, 4, v1
    v_mfma_f32_32x32x16_bf16 v[28:43], v[116:119], v[224:227], v[28:43]
    v_lshl_add_u32 v134, v6, 5, v134
    v_and_b32 v6, 3, v1
    s_waitcnt vmcnt(10)
    v_mfma_f32_32x32x16_bf16 v[12:27], v[120:123], v[228:231], v[12:27]
    v_lshl_add_u32 v134, v6, 3, v134
    v_add_u32 v134, s70, v134
    v_mfma_f32_32x32x16_bf16 v[28:43], v[124:127], v[228:231], v[28:43]
    v_and_b32 v132, 7, v1
    v_xor_b32 v132, s51, v132
    s_waitcnt vmcnt(9)
    v_mfma_f32_32x32x16_bf16 v[12:27], v[144:147], v[232:235], v[12:27]
    v_lshlrev_b32 v132, 4, v132
    v_lshl_add_u32 v132, v1, 7, v132
    v_mfma_f32_32x32x16_bf16 v[28:43], v[148:151], v[232:235], v[28:43]
    v_add_u32 v132, 147456, v132
    v_lshlrev_b32 v5, 7, v1
    s_waitcnt vmcnt(8)
    v_mfma_f32_32x32x16_bf16 v[12:27], v[152:155], v[236:239], v[12:27]
    v_mfma_f32_32x32x16_bf16 v[28:43], v[156:159], v[236:239], v[28:43]
    s_waitcnt vmcnt(7)
    v_mfma_f32_32x32x16_bf16 v[12:27], v[160:163], v[240:243], v[12:27]
    v_mfma_f32_32x32x16_bf16 v[28:43], v[164:167], v[240:243], v[28:43]
    s_waitcnt vmcnt(6)
    v_mfma_f32_32x32x16_bf16 v[12:27], v[168:171], v[244:247], v[12:27]
    v_mfma_f32_32x32x16_bf16 v[28:43], v[172:175], v[244:247], v[28:43]
    s_waitcnt vmcnt(5)
    v_mfma_f32_32x32x16_bf16 v[12:27], v[176:179], v[248:251], v[12:27]
    v_mfma_f32_32x32x16_bf16 v[28:43], v[180:183], v[248:251], v[28:43]
    s_waitcnt vmcnt(4)
    s_cmp_ge_u32 s51, 4
    s_nop 8
    s_cbranch_scc1 pb_48
    s_add_u32 s100, s45, 17563648
    v_lshlrev_b32 v70, 7, v1
    v_add_u32 v69, 2688, v70
    v_cmp_gt_u32 vcc, 7, v1
    s_nop 1
    v_cndmask_b32 v70, v69, v70, vcc
    v_mov_b32 v69, s50
    s_mov_b64 exec, 0x3fff
    buffer_load_dword v69, v70, s[4:7], s100 offen sc1
    s_mov_b64 exec, -1
pb_48:
    v_mfma_f32_32x32x16_bf16 v[12:27], v[184:187], v[252:255], v[12:27]
    v_mfma_f32_32x32x16_bf16 v[28:43], v[188:191], v[252:255], v[28:43]
    s_waitcnt vmcnt(3)
    v_mfma_f32_32x32x16_bf16 v[12:27], v[192:195], v[44:47], v[12:27]
    v_mfma_f32_32x32x16_bf16 v[28:43], v[196:199], v[44:47], v[28:43]
    s_waitcnt vmcnt(2)
    v_mfma_f32_32x32x16_bf16 v[12:27], v[200:203], v[48:51], v[12:27]
    v_mfma_f32_32x32x16_bf16 v[28:43], v[204:207], v[48:51], v[28:43]
    s_and_b32 s70, s51, 3
    s_lshl_b32 s70, s70, 2
    s_add_u32 s42, s70, 163416
    s_waitcnt vmcnt(0)
    s_cmp_ge_u32 s51, 4
    s_nop 5
    s_cbranch_scc1 sd_50
    v_cmp_ne_u32 vcc, s50, v69
    s_nop 3
    s_cbranch_vccz fast_49
    s_mov_b32 exec_lo, 0x3FFF
    s_mov_b32 exec_hi, 0
    s_mov_b32 s71, 0
poll_52:
    buffer_load_dword v2, v70, s[4:7], s100 offen sc1
    s_add_u32 s71, s71, 1
    s_waitcnt vmcnt(0)
    v_cmp_ne_u32 vcc, s50, v2
    s_nop 3
    s_cbranch_vccz polld_53
    s_cmp_lt_u32 s71, 400000
    s_cbranch_scc1 poll_52
polld_53:
    s_mov_b64 exec, -1
fast_49:
    v_mov_b32 v6, s42
    v_mov_b32 v5, 1
    s_mov_b64 exec, 1
    ds_add_u32 v6, v5
    s_mov_b64 exec, -1
    s_branch jn_51
sd_50:
    s_waitcnt lgkmcnt(0)
    v_mov_b32 v6, s42
    s_mov_b32 s70, 0
ls_55:
    ds_read_b32 v5, v6
    s_add_u32 s70, s70, 1
    s_waitcnt lgkmcnt(0)
    v_readfirstlane_b32 s71, v5
    s_nop 0
    s_cmp_ge_u32 s71, 1
    s_nop 1
    s_cbranch_scc1 lsd_56
    s_cmp_lt_u32 s70, 3200000
    s_cbranch_scc1 ls_55
lsd_56:
jn_51:
    s_add_u32 s71, s44, 0
    buffer_load_dwordx4 v[208:211], v9, s[4:7], s71 offen offset:0 sc1
    buffer_load_dwordx4 v[212:215], v9, s[4:7], s71 offen offset:1024 sc1
    buffer_load_dwordx4 v[216:219], v9, s[4:7], s71 offen offset:2048 sc1
    buffer_load_dwordx4 v[220:223], v9, s[4:7], s71 offen offset:3072 sc1
    s_add_u32 s71, s44, 4096
    buffer_load_dwordx4 v[224:227], v9, s[4:7], s71 offen offset:0 sc1
    buffer_load_dwordx4 v[228:231], v9, s[4:7], s71 offen offset:1024 sc1
    buffer_load_dwordx4 v[232:235], v9, s[4:7], s71 offen offset:2048 sc1
    buffer_load_dwordx4 v[236:239], v9, s[4:7], s71 offen offset:3072 sc1
    s_add_u32 s71, s44, 8192
    buffer_load_dwordx4 v[240:243], v9, s[4:7], s71 offen offset:0 sc1
    buffer_load_dwordx4 v[244:247], v9, s[4:7], s71 offen offset:1024 sc1
    buffer_load_dwordx4 v[248:251], v9, s[4:7], s71 offen offset:2048 sc1
    buffer_load_dwordx4 v[252:255], v9, s[4:7], s71 offen offset:3072 sc1
    s_add_u32 s71, s44, 12288
    buffer_load_dwordx4 v[44:47], v9, s[4:7], s71 offen offset:0 sc1
    buffer_load_dwordx4 v[48:51], v9, s[4:7], s71 offen offset:1024 sc1
    s_waitcnt lgkmcnt(0)
    v_mov_b32 v6, 163392
    s_mov_b32 s70, 0
ls_57:
    ds_read_b32 v5, v6
    s_add_u32 s70, s70, 1
    s_waitcnt lgkmcnt(0)
    v_readfirstlane_b32 s71, v5
    s_nop 0
    s_cmp_ge_u32 s71, 4
    s_nop 1
    s_cbranch_scc1 lsd_58
    s_cmp_lt_u32 s70, 3200000
    s_cbranch_scc1 ls_57
lsd_58:
    v_cvt_pk_bf16_f32 v12, v12, v13
    v_cvt_pk_bf16_f32 v13, v14, v15
    v_cvt_pk_bf16_f32 v14, v16, v17
    v_cvt_pk_bf16_f32 v15, v18, v19
    v_add_u32 v65, s99, v65
    v_cvt_pk_bf16_f32 v20, v20, v21
    v_cvt_pk_bf16_f32 v21, v22, v23
    v_cvt_pk_bf16_f32 v22, v24, v25
    v_cvt_pk_bf16_f32 v23, v26, v27
    v_add_u32 v66, s99, v66
    v_cvt_pk_bf16_f32 v28, v28, v29
    v_cvt_pk_bf16_f32 v29, v30, v31
    v_cvt_pk_bf16_f32 v30, v32, v33
    v_cvt_pk_bf16_f32 v31, v34, v35
    v_add_u32 v67, s99, v67
    v_cvt_pk_bf16_f32 v36, v36, v37
    v_cvt_pk_bf16_f32 v37, v38, v39
    v_cvt_pk_bf16_f32 v38, v40, v41
    v_cvt_pk_bf16_f32 v39, v42, v43
    v_add_u32 v68, s99, v68
    ds_write_b128 v65, v[12:15]
    ds_write_b128 v66, v[20:23]
    ds_write_b128 v67, v[28:31]
    ds_write_b128 v68, v[36:39]
    s_sub_u32 s46, s98, s99
    v_add_u32 v7, 114688, v11
    s_add_u32 s47, s48, 28672
    v_lshlrev_b32 v72, 16, v52
    v_and_b32 v73, 0xffff0000, v52
    v_lshlrev_b32 v74, 16, v53
    v_and_b32 v75, 0xffff0000, v53
    v_lshlrev_b32 v76, 16, v54
    v_and_b32 v77, 0xffff0000, v54
    v_lshlrev_b32 v78, 16, v55
    v_and_b32 v79, 0xffff0000, v55
    v_lshlrev_b32 v128, 16, v56
    v_and_b32 v129, 0xffff0000, v56
    v_lshlrev_b32 v130, 16, v57
    v_and_b32 v131, 0xffff0000, v57
    v_lshlrev_b32 v136, 16, v58
    v_and_b32 v137, 0xffff0000, v58
    v_lshlrev_b32 v138, 16, v59
    v_and_b32 v139, 0xffff0000, v59
    s_waitcnt lgkmcnt(0)
    s_waitcnt vmcnt(13)
    v_mfma_f32_32x32x16_bf16 v[12:27], v[80:83], v[208:211], 0
    v_mfma_f32_32x32x16_bf16 v[28:43], v[84:87], v[208:211], 0
    s_waitcnt vmcnt(12)
    v_mfma_f32_32x32x16_bf16 v[12:27], v[88:91], v[212:215], v[12:27]
    v_mfma_f32_32x32x16_bf16 v[28:43], v[92:95], v[212:215], v[28:43]
    s_waitcnt vmcnt(11)
    v_mfma_f32_32x32x16_bf16 v[12:27], v[96:99], v[216:219], v[12:27]
    v_mfma_f32_32x32x16_bf16 v[28:43], v[100:103], v[216:219], v[28:43]
    s_waitcnt vmcnt(10)
    v_mfma_f32_32x32x16_bf16 v[12:27], v[104:107], v[220:223], v[12:27]
    v_mfma_f32_32x32x16_bf16 v[28:43], v[108:111], v[220:223], v[28:43]
    s_waitcnt vmcnt(9)
    v_mfma_f32_32x32x16_bf16 v[12:27], v[112:115], v[224:227], v[12:27]
    v_mfma_f32_32x32x16_bf16 v[28:43], v[116:119], v[224:227], v[28:43]
    s_waitcnt vmcnt(8)
    v_mfma_f32_32x32x16_bf16 v[12:27], v[120:123], v[228:231], v[12:27]
    v_mfma_f32_32x32x16_bf16 v[28:43], v[124:127], v[228:231], v[28:43]
    s_waitcnt vmcnt(7)
    v_mfma_f32_32x32x16_bf16 v[12:27], v[144:147], v[232:235], v[12:27]
    v_mfma_f32_32x32x16_bf16 v[28:43], v[148:151], v[232:235], v[28:43]
    s_waitcnt vmcnt(6)
    v_mfma_f32_32x32x16_bf16 v[12:27], v[152:155], v[236:239], v[12:27]
    v_mfma_f32_32x32x16_bf16 v[28:43], v[156:159], v[236:239], v[28:43]
    s_waitcnt vmcnt(5)
    v_mfma_f32_32x32x16_bf16 v[12:27], v[160:163], v[240:243], v[12:27]
    v_mfma_f32_32x32x16_bf16 v[28:43], v[164:167], v[240:243], v[28:43]
    s_waitcnt vmcnt(4)
    v_mfma_f32_32x32x16_bf16 v[12:27], v[168:171], v[244:247], v[12:27]
    v_mfma_f32_32x32x16_bf16 v[28:43], v[172:175], v[244:247], v[28:43]
    s_waitcnt vmcnt(3)
    v_mfma_f32_32x32x16_bf16 v[12:27], v[176:179], v[248:251], v[12:27]
    v_mfma_f32_32x32x16_bf16 v[28:43], v[180:183], v[248:251], v[28:43]
    s_waitcnt vmcnt(2)
    v_mfma_f32_32x32x16_bf16 v[12:27], v[184:187], v[252:255], v[12:27]
    v_mfma_f32_32x32x16_bf16 v[28:43], v[188:191], v[252:255], v[28:43]
    s_waitcnt vmcnt(1)
    v_mfma_f32_32x32x16_bf16 v[12:27], v[192:195], v[44:47], v[12:27]
    v_mfma_f32_32x32x16_bf16 v[28:43], v[196:199], v[44:47], v[28:43]
    s_waitcnt vmcnt(0)
    v_mfma_f32_32x32x16_bf16 v[12:27], v[200:203], v[48:51], v[12:27]
    v_mfma_f32_32x32x16_bf16 v[28:43], v[204:207], v[48:51], v[28:43]
    s_nop 10
    v_cvt_pk_bf16_f32 v12, v12, v13
    v_cvt_pk_bf16_f32 v13, v14, v15
    v_cvt_pk_bf16_f32 v14, v16, v17
    v_cvt_pk_bf16_f32 v15, v18, v19
    v_add_u32 v65, s46, v65
    v_cvt_pk_bf16_f32 v20, v20, v21
    v_cvt_pk_bf16_f32 v21, v22, v23
    v_cvt_pk_bf16_f32 v22, v24, v25
    v_cvt_pk_bf16_f32 v23, v26, v27
    v_add_u32 v66, s46, v66
    v_cvt_pk_bf16_f32 v28, v28, v29
    v_cvt_pk_bf16_f32 v29, v30, v31
    v_cvt_pk_bf16_f32 v30, v32, v33
    v_cvt_pk_bf16_f32 v31, v34, v35
    v_add_u32 v67, s46, v67
    v_cvt_pk_bf16_f32 v36, v36, v37
    v_cvt_pk_bf16_f32 v37, v38, v39
    v_cvt_pk_bf16_f32 v38, v40, v41
    v_cvt_pk_bf16_f32 v39, v42, v43
    v_add_u32 v68, s46, v68
    ds_write_b128 v65, v[12:15]
    ds_write_b128 v66, v[20:23]
    ds_write_b128 v67, v[28:31]
    ds_write_b128 v68, v[36:39]
    s_cmp_ge_u32 s51, 4
    s_cbranch_scc1 st_59
    s_lshl_b32 s100, s92, 11
    s_add_u32 s100, s100, 17170432
    v_lshlrev_b32 v5, 7, v1
    v_add_u32 v6, 6144, v5
    v_cmp_lt_u32 vcc, 15, v1
    s_nop 1
    v_cndmask_b32 v70, v5, v6, vcc
    s_lshl_b32 s70, s92, 15
    s_lshl_b32 s71, s67, 1
    s_add_u32 s70, s70, s71
    s_add_u32 s42, s70, 14680064
    s_add_u32 s43, s42, 131072
    v_lshrrev_b32 v69, 3, v1
    v_lshlrev_b32 v69, 12, v69
    v_and_b32 v6, 7, v1
    v_lshl_add_u32 v69, v6, 4, v69
    s_mov_b32 exec_lo, -1
    s_mov_b32 exec_hi, 0
    s_mov_b32 s71, 0
poll_60:
    buffer_load_dword v2, v70, s[4:7], s100 offen sc1
    s_add_u32 s71, s71, 1
    s_waitcnt vmcnt(0)
    v_cmp_ne_u32 vcc, s50, v2
    s_nop 3
    s_cbranch_vccz polld_61
    s_cmp_lt_u32 s71, 400000
    s_cbranch_scc1 poll_60
polld_61:
    s_mov_b64 exec, -1
    buffer_load_dwordx4 v[208:211], v69, s[4:7], s42 offen sc1
    buffer_load_dwordx4 v[212:215], v69, s[4:7], s43 offen sc1
    v_xor_b32 v70, 64, v132
    s_waitcnt vmcnt(1)
    ds_write_b128 v135, v[208:211] offset:8192
    ds_read_b64_tr_b16 v[208:209], v134 offset:8192
    ds_read_b64_tr_b16 v[210:211], v134 offset:8704
    s_waitcnt vmcnt(0)
    ds_write_b128 v135, v[212:215] offset:9216
    ds_read_b64_tr_b16 v[212:213], v134 offset:9216
    ds_read_b64_tr_b16 v[214:215], v134 offset:9728
    s_waitcnt lgkmcnt(0)
    ds_write_b128 v132, v[208:211]
    ds_write_b128 v70, v[212:215]
st_59:
    s_mov_b32 s70, 0x3f80
    s_mov_b32 s71, 0x3f800000
    s_waitcnt lgkmcnt(0)
    s_barrier
    ds_read_b64 v[208:209], v11 offset:0
    ds_read_b64 v[210:211], v11 offset:10240
    ds_read_b64 v[212:213], v11 offset:20480
    ds_read_b64 v[214:215], v11 offset:30720
    ds_read_b64 v[216:217], v11 offset:40960
    ds_read_b64 v[218:219], v11 offset:45056
    ds_read_b64 v[220:221], v11 offset:49152
    ds_read_b64 v[222:223], v11 offset:53248
    ds_read_b64 v[60:61], v64 offset:0
    ds_read_b64 v[62:63], v64 offset:4096
    s_waitcnt lgkmcnt(9)
    ds_read_b64 v[224:225], v7 offset:0
    v_dot2_f32_bf16 v72, v208, s70, v72
    v_dot2_f32_bf16 v73, v208, s71, v73
    v_dot2_f32_bf16 v74, v209, s70, v74
    v_dot2_f32_bf16 v75, v209, s71, v75
    s_waitcnt lgkmcnt(9)
    ds_read_b64 v[226:227], v7 offset:4096
    v_dot2_f32_bf16 v72, v210, s70, v72
    v_dot2_f32_bf16 v73, v210, s71, v73
    v_dot2_f32_bf16 v74, v211, s70, v74
    v_dot2_f32_bf16 v75, v211, s71, v75
    s_waitcnt lgkmcnt(9)
    ds_read_b64 v[228:229], v7 offset:8192
    v_dot2_f32_bf16 v72, v212, s70, v72
    v_dot2_f32_bf16 v73, v212, s71, v73
    v_dot2_f32_bf16 v74, v213, s70, v74
    v_dot2_f32_bf16 v75, v213, s71, v75
    s_waitcnt lgkmcnt(9)
    ds_read_b64 v[230:231], v7 offset:12288
    v_dot2_f32_bf16 v72, v214, s70, v72
    v_dot2_f32_bf16 v73, v214, s71, v73
    v_dot2_f32_bf16 v74, v215, s70, v74
    v_dot2_f32_bf16 v75, v215, s71, v75
    s_waitcnt lgkmcnt(9)
    ds_read_b64 v[232:233], v7 offset:16384
    v_dot2_f32_bf16 v72, v216, s70, v72
    v_dot2_f32_bf16 v73, v216, s71, v73
    v_dot2_f32_bf16 v74, v217, s70, v74
    v_dot2_f32_bf16 v75, v217, s71, v75
    s_waitcnt lgkmcnt(9)
    ds_read_b64 v[234:235], v7 offset:20480
    v_dot2_f32_bf16 v72, v218, s70, v72
    v_dot2_f32_bf16 v73, v218, s71, v73
    v_dot2_f32_bf16 v74, v219, s70, v74
    v_dot2_f32_bf16 v75, v219, s71, v75
    s_waitcnt lgkmcnt(9)
    ds_read_b64 v[236:237], v7 offset:24576
    v_dot2_f32_bf16 v72, v220, s70, v72
    v_dot2_f32_bf16 v73, v220, s71, v73
    v_dot2_f32_bf16 v74, v221, s70, v74
    v_dot2_f32_bf16 v75, v221, s71, v75
    s_waitcnt lgkmcnt(9)
    ds_read_b64 v[238:239], v7 offset:28672
    v_dot2_f32_bf16 v72, v222, s70, v72
    v_dot2_f32_bf16 v73, v222, s71, v73
    v_dot2_f32_bf16 v74, v223, s70, v74
    v_dot2_f32_bf16 v75, v223, s71, v75
    s_waitcnt lgkmcnt(7)
    v_dot2_f32_bf16 v76, v224, s70, v76
    v_dot2_f32_bf16 v77, v224, s71, v77
    v_dot2_f32_bf16 v78, v225, s70, v78
    v_dot2_f32_bf16 v79, v225, s71, v79
    s_waitcnt lgkmcnt(6)
    v_dot2_f32_bf16 v76, v226, s70, v76
    v_dot2_f32_bf16 v77, v226, s71, v77
    v_dot2_f32_bf16 v78, v227, s70, v78
    v_dot2_f32_bf16 v79, v227, s71, v79
    s_waitcnt lgkmcnt(5)
    v_dot2_f32_bf16 v76, v228, s70, v76
    v_dot2_f32_bf16 v77, v228, s71, v77
    v_dot2_f32_bf16 v78, v229, s70, v78
    v_dot2_f32_bf16 v79, v229, s71, v79
    s_waitcnt lgkmcnt(4)
    v_dot2_f32_bf16 v76, v230, s70, v76
    v_dot2_f32_bf16 v77, v230, s71, v77
    v_dot2_f32_bf16 v78, v231, s70, v78
    v_dot2_f32_bf16 v79, v231, s71, v79
    s_waitcnt lgkmcnt(3)
    v_dot2_f32_bf16 v76, v232, s70, v76
    v_dot2_f32_bf16 v77, v232, s71, v77
    v_dot2_f32_bf16 v78, v233, s70, v78
    v_dot2_f32_bf16 v79, v233, s71, v79
    s_waitcnt lgkmcnt(2)
    v_dot2_f32_bf16 v76, v234, s70, v76
    v_dot2_f32_bf16 v77, v234, s71, v77
    v_dot2_f32_bf16 v78, v235, s70, v78
    v_dot2_f32_bf16 v79, v235, s71, v79
    s_waitcnt lgkmcnt(1)
    v_dot2_f32_bf16 v76, v236, s70, v76
    v_dot2_f32_bf16 v77, v236, s71, v77
    v_dot2_f32_bf16 v78, v237, s70, v78
    v_dot2_f32_bf16 v79, v237, s71, v79
    s_waitcnt lgkmcnt(0)
    v_dot2_f32_bf16 v76, v238, s70, v76
    v_dot2_f32_bf16 v77, v238, s71, v77
    v_dot2_f32_bf16 v78, v239, s70, v78
    v_dot2_f32_bf16 v79, v239, s71, v79
    v_mul_f32 v12, 3216550459, v72
    v_mul_f32 v13, 3216550459, v73
    v_mul_f32 v14, 3216550459, v74
    v_mul_f32 v15, 3216550459, v75
    v_exp_f32 v12, v12
    v_exp_f32 v13, v13
    v_exp_f32 v14, v14
    v_exp_f32 v15, v15
    v_lshlrev_b32 v16, 16, v60
    v_and_b32 v17, 0xffff0000, v60
    v_lshlrev_b32 v18, 16, v61
    v_and_b32 v19, 0xffff0000, v61
    v_add_f32 v12, 1.0, v12
    v_add_f32 v13, 1.0, v13
    v_add_f32 v14, 1.0, v14
    v_add_f32 v15, 1.0, v15
    v_rcp_f32 v12, v12
    v_rcp_f32 v13, v13
    v_rcp_f32 v14, v14
    v_rcp_f32 v15, v15
    v_mul_f32 v16, v16, v72
    v_mul_f32 v17, v17, v73
    v_mul_f32 v18, v18, v74
    v_mul_f32 v19, v19, v75
    v_fma_f32 v12, v12, v16, v128
    v_fma_f32 v13, v13, v17, v129
    v_fma_f32 v14, v14, v18, v130
    v_fma_f32 v15, v15, v19, v131
    v_cvt_pk_bf16_f32 v20, v12, v13
    v_cvt_pk_bf16_f32 v21, v14, v15
    buffer_store_dwordx2 v[20:21], v10, s[8:11], s48 offen
    v_mul_f32 v28, 3216550459, v76
    v_mul_f32 v29, 3216550459, v77
    v_mul_f32 v30, 3216550459, v78
    v_mul_f32 v31, 3216550459, v79
    v_exp_f32 v28, v28
    v_exp_f32 v29, v29
    v_exp_f32 v30, v30
    v_exp_f32 v31, v31
    v_lshlrev_b32 v32, 16, v62
    v_and_b32 v33, 0xffff0000, v62
    v_lshlrev_b32 v34, 16, v63
    v_and_b32 v35, 0xffff0000, v63
    v_add_f32 v28, 1.0, v28
    v_add_f32 v29, 1.0, v29
    v_add_f32 v30, 1.0, v30
    v_add_f32 v31, 1.0, v31
    v_rcp_f32 v28, v28
    v_rcp_f32 v29, v29
    v_rcp_f32 v30, v30
    v_rcp_f32 v31, v31
    v_mul_f32 v32, v32, v76
    v_mul_f32 v33, v33, v77
    v_mul_f32 v34, v34, v78
    v_mul_f32 v35, v35, v79
    v_fma_f32 v28, v28, v32, v136
    v_fma_f32 v29, v29, v33, v137
    v_fma_f32 v30, v30, v34, v138
    v_fma_f32 v31, v31, v35, v139
    v_cvt_pk_bf16_f32 v36, v28, v29
    v_cvt_pk_bf16_f32 v37, v30, v31
    buffer_store_dwordx2 v[36:37], v10, s[8:11], s47 offen
    s_endpgm
L_helper:
    s_sub_u32 s93, s64, 224
    s_lshl_b32 s92, s93, 3
    s_add_u32 s92, s92, s51
    s_lshl_b32 s99, s51, 13
    s_add_u32 s99, s99, 57344
    v_lshrrev_b32 v5, 3, v1
    v_and_b32 v6, 7, v1
    v_lshlrev_b32 v7, 1, v5
    v_and_b32 v7, 4, v7
    v_xor_b32 v7, v6, v7
    v_mul_u32_u24 v10, 3584, v5
    v_lshl_add_u32 v10, v7, 4, v10
    v_mul_u32_u24 v5, 896, v5
    v_lshl_add_u32 v8, v7, 4, v5
    s_and_b32 s95, s51, 3
    s_mul_i32 s97, s95, 14336
    s_lshr_b32 s96, s51, 2
    v_bfe_u32 v5, v1, 2, 2
    v_lshrrev_b32 v6, 5, v1
    v_lshl_add_u32 v6, v6, 2, v5
    v_lshlrev_b32 v11, 7, v6
    v_lshrrev_b32 v5, 1, v5
    v_xor_b32 v5, s96, v5
    v_lshl_add_u32 v11, v5, 6, v11
    v_bfe_u32 v5, v1, 4, 1
    v_lshl_add_u32 v11, v5, 5, v11
    v_and_b32 v5, 3, v1
    v_lshl_add_u32 v11, v5, 3, v11
    v_add_u32 v11, s97, v11
    v_bfe_u32 v5, v1, 2, 2
    v_lshrrev_b32 v6, 5, v1
    v_lshl_add_u32 v6, v6, 2, v5
    v_lshlrev_b32 v12, 7, v6
    v_lshrrev_b32 v5, 1, v5
    v_xor_b32 v5, 0, v5
    v_lshl_add_u32 v12, v5, 6, v12
    v_bfe_u32 v5, v1, 4, 1
    v_lshl_add_u32 v12, v5, 5, v12
    v_and_b32 v5, 3, v1
    v_lshl_add_u32 v12, v5, 3, v12
    v_add_u32 v12, s99, v12
    s_waitcnt lgkmcnt(0)
    s_mov_b32 s4, s48
    s_and_b32 s5, s49, 0xffff
    s_mov_b32 s6, 268435456
    s_mov_b32 s7, 0x20000
    s_mov_b32 s56, s40
    s_and_b32 s57, s41, 0xffff
    s_mov_b32 s58, 1605632
    s_mov_b32 s59, 0x20000
    s_mov_b32 s60, s42
    s_and_b32 s61, s43, 0xffff
    s_mov_b32 s62, 1605632
    s_mov_b32 s63, 0x20000
    s_cmp_ge_u32 s92, 224
    s_cbranch_scc1 L_hidle
    s_lshl_b32 s70, s93, 7
    s_mul_i32 s71, s95, 401408
    s_add_u32 s70, s70, s71
    s_mul_i32 s71, s96, 200704
    s_add_u32 s20, s70, s71
    s_mul_i32 s71, s96, 7168
    s_add_u32 s21, s97, s71
    s_lshr_b32 s70, s93, 2
    s_lshl_b32 s70, s70, 1
    s_and_b32 s71, s93, 1
    s_add_u32 s70, s70, s71
    s_lshl_b32 s70, s70, 2
    s_lshr_b32 s71, s51, 1
    s_add_u32 s94, s70, s71
    s_and_b32 s70, s93, 2
    s_and_b32 s71, s51, 1
    s_add_u32 s95, s70, s71
    s_lshl_b32 s22, s94, 2
    s_add_u32 s22, s22, s95
    s_and_b32 s70, s94, 7
    s_mul_i32 s70, s70, 200704
    s_lshr_b32 s71, s94, 3
    s_lshl_b32 s71, s71, 7
    s_add_u32 s70, s70, s71
    s_mul_i32 s71, s95, 7
    s_lshr_b32 s71, s71, 1
    s_mul_i32 s71, s71, 14336
    s_add_u32 s23, s70, s71
    s_bitcmp1_b32 s93, 1
    s_cbranch_scc1 L_hside
    s_mov_b32 m0, s99
    s_nop 0
    buffer_load_dwordx4 v8, s[60:63], s23 offen lds
    s_add_u32 s23, s23, 7168
    s_add_u32 m0, m0, 1024
    s_nop 0
    buffer_load_dwordx4 v8, s[60:63], s23 offen lds
    s_add_u32 s23, s23, 7168
    s_add_u32 m0, m0, 1024
    s_nop 0
    buffer_load_dwordx4 v8, s[60:63], s23 offen lds
    s_add_u32 s23, s23, 7168
    s_add_u32 m0, m0, 1024
    s_nop 0
    buffer_load_dwordx4 v8, s[60:63], s23 offen lds
    s_add_u32 s23, s23, 7168
    s_add_u32 m0, m0, 1024
    s_nop 0
    buffer_load_dwordx4 v8, s[60:63], s23 offen lds
    s_add_u32 s23, s23, 7168
    s_add_u32 m0, m0, 1024
    s_nop 0
    buffer_load_dwordx4 v8, s[60:63], s23 offen lds
    s_add_u32 s23, s23, 7168
    s_add_u32 m0, m0, 1024
    s_nop 0
    buffer_load_dwordx4 v8, s[60:63], s23 offen lds
    s_add_u32 s23, s23, 7168
    s_add_u32 m0, m0, 1024
    s_nop 0
    buffer_load_dwordx4 v8, s[60:63], s23 offen lds
    s_add_u32 s23, s23, 7168
    s_add_u32 m0, m0, 1024
    buffer_load_dword v4, v3, s[4:7], 0 offen sc1
    s_and_b32 s70, s95, 1
    s_lshl_b32 s71, s70, 6
    v_xor_b32 v12, s71, v12
    v_xor_b32 v13, 64, v12
    s_lshl_b32 s70, s70, 11
    v_add_u32 v13, s70, v13
    s_mul_i32 s100, s92, 7168
    s_add_u32 s100, s100, 18874368
    s_mul_i32 s101, s22, 7168
    s_add_u32 s101, s101, 20971520
    s_lshl_b32 s24, s92, 7
    s_add_u32 s25, s24, 327680
    s_add_u32 s24, s24, 16908288
    s_lshl_b32 s26, s22, 7
    s_add_u32 s26, s26, 16936960
    v_mov_b32 v14, 0
    v_mov_b32 v15, 0
    s_waitcnt vmcnt(7)
    ds_read_b64_tr_b16 v[48:49], v12 offset:0
    ds_read_b64_tr_b16 v[50:51], v12 offset:1024
    s_waitcnt vmcnt(5)
    ds_read_b64_tr_b16 v[52:53], v13 offset:0
    ds_read_b64_tr_b16 v[54:55], v13 offset:1024
    ds_read_b64_tr_b16 v[56:57], v12 offset:2048
    ds_read_b64_tr_b16 v[58:59], v12 offset:3072
    s_waitcnt vmcnt(3)
    ds_read_b64_tr_b16 v[60:61], v13 offset:2048
    ds_read_b64_tr_b16 v[62:63], v13 offset:3072
    ds_read_b64_tr_b16 v[64:65], v12 offset:4096
    ds_read_b64_tr_b16 v[66:67], v12 offset:5120
    s_waitcnt vmcnt(1)
    ds_read_b64_tr_b16 v[68:69], v13 offset:4096
    ds_read_b64_tr_b16 v[70:71], v13 offset:5120
    ds_read_b64_tr_b16 v[72:73], v12 offset:6144
    ds_read_b64_tr_b16 v[74:75], v12 offset:7168
    s_waitcnt lgkmcnt(12)
    buffer_store_dwordx4 v[48:51], v9, s[4:7], s101 offen offset:0 sc1
    s_waitcnt lgkmcnt(10)
    buffer_store_dwordx4 v[52:55], v9, s[4:7], s101 offen offset:1024 sc1
    s_waitcnt lgkmcnt(8)
    buffer_store_dwordx4 v[56:59], v9, s[4:7], s101 offen offset:2048 sc1
    s_waitcnt lgkmcnt(6)
    buffer_store_dwordx4 v[60:63], v9, s[4:7], s101 offen offset:3072 sc1
    s_add_u32 s101, s101, 4096
    s_waitcnt lgkmcnt(4)
    buffer_store_dwordx4 v[64:67], v9, s[4:7], s101 offen offset:0 sc1
    s_waitcnt lgkmcnt(2)
    buffer_store_dwordx4 v[68:71], v9, s[4:7], s101 offen offset:1024 sc1
    s_waitcnt lgkmcnt(0)
    buffer_store_dwordx4 v[72:75], v9, s[4:7], s101 offen offset:2048 sc1
    s_waitcnt vmcnt(7)
    v_readfirstlane_b32 s70, v4
    s_nop 0
    s_mul_i32 s50, s70, 0x9E3779B1
    s_add_u32 s50, s50, 0x7F4A7C15
    v_mov_b32 v4, s50
    v_mov_b32 v128, s50
    s_getreg_b32 s70, hwreg(HW_REG_XCC_ID)
    v_mov_b32 v129, s70
    v_mov_b32 v130, s50
    v_mov_b32 v131, s50
    s_barrier
    s_waitcnt vmcnt(0)
    s_mov_b64 exec, 0xff
    buffer_store_dwordx4 v[128:131], v9, s[4:7], s26 offen sc1
    s_mov_b64 exec, -1
    s_mov_b32 m0, s21
    s_nop 0
    buffer_load_dwordx4 v10, s[56:59], s20 offen lds
    s_add_u32 s20, s20, 28672
    s_add_u32 m0, m0, 1024
    s_nop 0
    buffer_load_dwordx4 v10, s[56:59], s20 offen lds
    s_add_u32 s20, s20, 28672
    s_add_u32 m0, m0, 1024
    s_nop 0
    buffer_load_dwordx4 v10, s[56:59], s20 offen lds
    s_add_u32 s20, s20, 28672
    s_add_u32 m0, m0, 1024
    s_nop 0
    buffer_load_dwordx4 v10, s[56:59], s20 offen lds
    s_add_u32 s20, s20, 28672
    s_add_u32 m0, m0, 1024
    s_nop 0
    buffer_load_dwordx4 v10, s[56:59], s20 offen lds
    s_add_u32 s20, s20, 28672
    s_add_u32 m0, m0, 1024
    s_nop 0
    buffer_load_dwordx4 v10, s[56:59], s20 offen lds
    s_add_u32 s20, s20, 28672
    s_add_u32 m0, m0, 1024
    s_nop 0
    buffer_load_dwordx4 v10, s[56:59], s20 offen lds
    s_add_u32 s20, s20, 28672
    s_add_u32 m0, m0, 1024
    s_waitcnt vmcnt(0)
    s_barrier
    ds_read_b64_tr_b16 v[20:21], v11 offset:0
    ds_read_b64_tr_b16 v[22:23], v11 offset:1024
    ds_read_b64_tr_b16 v[24:25], v11 offset:2048
    ds_read_b64_tr_b16 v[26:27], v11 offset:3072
    ds_read_b64_tr_b16 v[28:29], v11 offset:4096
    ds_read_b64_tr_b16 v[30:31], v11 offset:5120
    ds_read_b64_tr_b16 v[32:33], v11 offset:6144
    ds_read_b64_tr_b16 v[34:35], v11 offset:7168
    ds_read_b64_tr_b16 v[36:37], v11 offset:8192
    ds_read_b64_tr_b16 v[38:39], v11 offset:9216
    ds_read_b64_tr_b16 v[40:41], v11 offset:10240
    ds_read_b64_tr_b16 v[42:43], v11 offset:11264
    ds_read_b64_tr_b16 v[44:45], v11 offset:12288
    ds_read_b64_tr_b16 v[46:47], v11 offset:13312
    s_waitcnt lgkmcnt(0)
    s_mov_b32 s71, 0x3f803f80
    v_dot2_f32_bf16 v14, v20, s71, v14
    v_dot2_f32_bf16 v15, v21, s71, v15
    v_dot2_f32_bf16 v14, v22, s71, v14
    v_dot2_f32_bf16 v15, v23, s71, v15
    v_dot2_f32_bf16 v14, v24, s71, v14
    v_dot2_f32_bf16 v15, v25, s71, v15
    v_dot2_f32_bf16 v14, v26, s71, v14
    v_dot2_f32_bf16 v15, v27, s71, v15
    v_dot2_f32_bf16 v14, v28, s71, v14
    v_dot2_f32_bf16 v15, v29, s71, v15
    v_dot2_f32_bf16 v14, v30, s71, v14
    v_dot2_f32_bf16 v15, v31, s71, v15
    v_dot2_f32_bf16 v14, v32, s71, v14
    v_dot2_f32_bf16 v15, v33, s71, v15
    v_dot2_f32_bf16 v14, v34, s71, v14
    v_dot2_f32_bf16 v15, v35, s71, v15
    v_dot2_f32_bf16 v14, v36, s71, v14
    v_dot2_f32_bf16 v15, v37, s71, v15
    v_dot2_f32_bf16 v14, v38, s71, v14
    v_dot2_f32_bf16 v15, v39, s71, v15
    v_dot2_f32_bf16 v14, v40, s71, v14
    v_dot2_f32_bf16 v15, v41, s71, v15
    v_dot2_f32_bf16 v14, v42, s71, v14
    v_dot2_f32_bf16 v15, v43, s71, v15
    v_dot2_f32_bf16 v14, v44, s71, v14
    v_dot2_f32_bf16 v15, v45, s71, v15
    v_dot2_f32_bf16 v14, v46, s71, v14
    v_dot2_f32_bf16 v15, v47, s71, v15
    s_nop 2
    v_add_f32 v14, v14, v15
    v_mov_b32 v15, v14
    v_lshlrev_b32 v5, 2, v1
    s_nop 0
    v_permlane32_swap_b32 v15, v14
    v_add_f32 v14, v14, v15
    s_mov_b32 exec_hi, 0
    buffer_store_dword v14, v5, s[4:7], s25 offen sc1
    s_mov_b32 exec_hi, -1
    s_waitcnt vmcnt(0)
    s_mov_b64 exec, 0xff
    buffer_store_dwordx4 v[128:131], v9, s[4:7], s24 offen sc1
    s_mov_b64 exec, -1
    s_branch L_hwarm
L_hside:
    s_mov_b32 m0, s21
    s_nop 0
    buffer_load_dwordx4 v10, s[56:59], s20 offen lds
    s_add_u32 s20, s20, 28672
    s_add_u32 m0, m0, 1024
    s_nop 0
    buffer_load_dwordx4 v10, s[56:59], s20 offen lds
    s_add_u32 s20, s20, 28672
    s_add_u32 m0, m0, 1024
    s_nop 0
    buffer_load_dwordx4 v10, s[56:59], s20 offen lds
    s_add_u32 s20, s20, 28672
    s_add_u32 m0, m0, 1024
    s_nop 0
    buffer_load_dwordx4 v10, s[56:59], s20 offen lds
    s_add_u32 s20, s20, 28672
    s_add_u32 m0, m0, 1024
    s_nop 0
    buffer_load_dwordx4 v10, s[56:59], s20 offen lds
    s_add_u32 s20, s20, 28672
    s_add_u32 m0, m0, 1024
    s_nop 0
    buffer_load_dwordx4 v10, s[56:59], s20 offen lds
    s_add_u32 s20, s20, 28672
    s_add_u32 m0, m0, 1024
    s_nop 0
    buffer_load_dwordx4 v10, s[56:59], s20 offen lds
    s_add_u32 s20, s20, 28672
    s_add_u32 m0, m0, 1024
    buffer_load_dword v4, v3, s[4:7], 0 offen sc1
    s_and_b32 s70, s95, 1
    s_lshl_b32 s71, s70, 6
    v_xor_b32 v12, s71, v12
    v_xor_b32 v13, 64, v12
    s_lshl_b32 s70, s70, 11
    v_add_u32 v13, s70, v13
    s_mul_i32 s100, s92, 7168
    s_add_u32 s100, s100, 18874368
    s_mul_i32 s101, s22, 7168
    s_add_u32 s101, s101, 20971520
    s_lshl_b32 s24, s92, 7
    s_add_u32 s25, s24, 327680
    s_add_u32 s24, s24, 16908288
    s_lshl_b32 s26, s22, 7
    s_add_u32 s26, s26, 16936960
    v_mov_b32 v14, 0
    v_mov_b32 v15, 0
    s_waitcnt vmcnt(1)
    s_barrier
    ds_read_b64_tr_b16 v[20:21], v11 offset:0
    ds_read_b64_tr_b16 v[22:23], v11 offset:1024
    ds_read_b64_tr_b16 v[24:25], v11 offset:2048
    ds_read_b64_tr_b16 v[26:27], v11 offset:3072
    ds_read_b64_tr_b16 v[28:29], v11 offset:4096
    ds_read_b64_tr_b16 v[30:31], v11 offset:5120
    ds_read_b64_tr_b16 v[32:33], v11 offset:6144
    ds_read_b64_tr_b16 v[34:35], v11 offset:7168
    ds_read_b64_tr_b16 v[36:37], v11 offset:8192
    ds_read_b64_tr_b16 v[38:39], v11 offset:9216
    ds_read_b64_tr_b16 v[40:41], v11 offset:10240
    ds_read_b64_tr_b16 v[42:43], v11 offset:11264
    ds_read_b64_tr_b16 v[44:45], v11 offset:12288
    ds_read_b64_tr_b16 v[46:47], v11 offset:13312
    s_waitcnt lgkmcnt(12)
    buffer_store_dwordx4 v[20:23], v9, s[4:7], s100 offen offset:0 sc1
    s_waitcnt lgkmcnt(10)
    buffer_store_dwordx4 v[24:27], v9, s[4:7], s100 offen offset:1024 sc1
    s_waitcnt lgkmcnt(8)
    buffer_store_dwordx4 v[28:31], v9, s[4:7], s100 offen offset:2048 sc1
    s_waitcnt lgkmcnt(6)
    buffer_store_dwordx4 v[32:35], v9, s[4:7], s100 offen offset:3072 sc1
    s_add_u32 s100, s100, 4096
    s_waitcnt lgkmcnt(4)
    buffer_store_dwordx4 v[36:39], v9, s[4:7], s100 offen offset:0 sc1
    s_waitcnt lgkmcnt(2)
    buffer_store_dwordx4 v[40:43], v9, s[4:7], s100 offen offset:1024 sc1
    s_waitcnt lgkmcnt(0)
    buffer_store_dwordx4 v[44:47], v9, s[4:7], s100 offen offset:2048 sc1
    s_mov_b32 s71, 0x3f803f80
    v_dot2_f32_bf16 v14, v20, s71, v14
    v_dot2_f32_bf16 v15, v21, s71, v15
    v_dot2_f32_bf16 v14, v22, s71, v14
    v_dot2_f32_bf16 v15, v23, s71, v15
    v_dot2_f32_bf16 v14, v24, s71, v14
    v_dot2_f32_bf16 v15, v25, s71, v15
    v_dot2_f32_bf16 v14, v26, s71, v14
    v_dot2_f32_bf16 v15, v27, s71, v15
    v_dot2_f32_bf16 v14, v28, s71, v14
    v_dot2_f32_bf16 v15, v29, s71, v15
    v_dot2_f32_bf16 v14, v30, s71, v14
    v_dot2_f32_bf16 v15, v31, s71, v15
    v_dot2_f32_bf16 v14, v32, s71, v14
    v_dot2_f32_bf16 v15, v33, s71, v15
    v_dot2_f32_bf16 v14, v34, s71, v14
    v_dot2_f32_bf16 v15, v35, s71, v15
    v_dot2_f32_bf16 v14, v36, s71, v14
    v_dot2_f32_bf16 v15, v37, s71, v15
    v_dot2_f32_bf16 v14, v38, s71, v14
    v_dot2_f32_bf16 v15, v39, s71, v15
    v_dot2_f32_bf16 v14, v40, s71, v14
    v_dot2_f32_bf16 v15, v41, s71, v15
    v_dot2_f32_bf16 v14, v42, s71, v14
    v_dot2_f32_bf16 v15, v43, s71, v15
    v_dot2_f32_bf16 v14, v44, s71, v14
    v_dot2_f32_bf16 v15, v45, s71, v15
    v_dot2_f32_bf16 v14, v46, s71, v14
    v_dot2_f32_bf16 v15, v47, s71, v15
    s_nop 2
    v_add_f32 v14, v14, v15
    v_mov_b32 v15, v14
    v_lshlrev_b32 v5, 2, v1
    s_nop 0
    v_permlane32_swap_b32 v15, v14
    v_add_f32 v14, v14, v15
    s_mov_b32 exec_hi, 0
    buffer_store_dword v14, v5, s[4:7], s25 offen sc1
    s_mov_b32 exec_hi, -1
    s_barrier
    s_mov_b32 m0, s99
    s_nop 0
    buffer_load_dwordx4 v8, s[60:63], s23 offen lds
    s_add_u32 s23, s23, 7168
    s_add_u32 m0, m0, 1024
    s_nop 0
    buffer_load_dwordx4 v8, s[60:63], s23 offen lds
    s_add_u32 s23, s23, 7168
    s_add_u32 m0, m0, 1024
    s_nop 0
    buffer_load_dwordx4 v8, s[60:63], s23 offen lds
    s_add_u32 s23, s23, 7168
    s_add_u32 m0, m0, 1024
    s_nop 0
    buffer_load_dwordx4 v8, s[60:63], s23 offen lds
    s_add_u32 s23, s23, 7168
    s_add_u32 m0, m0, 1024
    s_waitcnt vmcnt(12)
    v_readfirstlane_b32 s70, v4
    s_nop 0
    s_mul_i32 s50, s70, 0x9E3779B1
    s_add_u32 s50, s50, 0x7F4A7C15
    v_mov_b32 v4, s50
    v_mov_b32 v128, s50
    s_getreg_b32 s70, hwreg(HW_REG_XCC_ID)
    v_mov_b32 v129, s70
    v_mov_b32 v130, s50
    v_mov_b32 v131, s50
    s_waitcnt vmcnt(4)
    s_mov_b64 exec, 0xff
    buffer_store_dwordx4 v[128:131], v9, s[4:7], s24 offen sc1
    s_mov_b64 exec, -1
    buffer_load_dwordx4 v8, s[60:63], s23 offen lds
    s_add_u32 s23, s23, 7168
    s_add_u32 m0, m0, 1024
    s_nop 0
    buffer_load_dwordx4 v8, s[60:63], s23 offen lds
    s_add_u32 s23, s23, 7168
    s_add_u32 m0, m0, 1024
    s_nop 0
    buffer_load_dwordx4 v8, s[60:63], s23 offen lds
    s_add_u32 s23, s23, 7168
    s_add_u32 m0, m0, 1024
    s_nop 0
    buffer_load_dwordx4 v8, s[60:63], s23 offen lds
    s_add_u32 s23, s23, 7168
    s_add_u32 m0, m0, 1024
    s_waitcnt vmcnt(7)
    ds_read_b64_tr_b16 v[48:49], v12 offset:0
    ds_read_b64_tr_b16 v[50:51], v12 offset:1024
    s_waitcnt vmcnt(5)
    ds_read_b64_tr_b16 v[52:53], v13 offset:0
    ds_read_b64_tr_b16 v[54:55], v13 offset:1024
    ds_read_b64_tr_b16 v[56:57], v12 offset:2048
    ds_read_b64_tr_b16 v[58:59], v12 offset:3072
    s_waitcnt vmcnt(2)
    ds_read_b64_tr_b16 v[60:61], v13 offset:2048
    ds_read_b64_tr_b16 v[62:63], v13 offset:3072
    ds_read_b64_tr_b16 v[64:65], v12 offset:4096
    ds_read_b64_tr_b16 v[66:67], v12 offset:5120
    s_waitcnt vmcnt(0)
    ds_read_b64_tr_b16 v[68:69], v13 offset:4096
    ds_read_b64_tr_b16 v[70:71], v13 offset:5120
    ds_read_b64_tr_b16 v[72:73], v12 offset:6144
    ds_read_b64_tr_b16 v[74:75], v12 offset:7168
    s_waitcnt lgkmcnt(12)
    buffer_store_dwordx4 v[48:51], v9, s[4:7], s101 offen offset:0 sc1
    s_waitcnt lgkmcnt(10)
    buffer_store_dwordx4 v[52:55], v9, s[4:7], s101 offen offset:1024 sc1
    s_waitcnt lgkmcnt(8)
    buffer_store_dwordx4 v[56:59], v9, s[4:7], s101 offen offset:2048 sc1
    s_waitcnt lgkmcnt(6)
    buffer_store_dwordx4 v[60:63], v9, s[4:7], s101 offen offset:3072 sc1
    s_add_u32 s101, s101, 4096
    s_waitcnt lgkmcnt(4)
    buffer_store_dwordx4 v[64:67], v9, s[4:7], s101 offen offset:0 sc1
    s_waitcnt lgkmcnt(2)
    buffer_store_dwordx4 v[68:71], v9, s[4:7], s101 offen offset:1024 sc1
    s_waitcnt lgkmcnt(0)
    buffer_store_dwordx4 v[72:75], v9, s[4:7], s101 offen offset:2048 sc1
    s_waitcnt vmcnt(0)
    s_mov_b64 exec, 0xff
    buffer_store_dwordx4 v[128:131], v9, s[4:7], s26 offen sc1
    s_mov_b64 exec, -1
    s_branch L_hwarm
L_hidle:
    buffer_load_dword v4, v3, s[4:7], 0 offen sc1
    s_waitcnt vmcnt(0)
    v_readfirstlane_b32 s70, v4
    s_nop 0
    s_mul_i32 s50, s70, 0x9E3779B1
    s_add_u32 s50, s50, 0x7F4A7C15
    v_mov_b32 v4, s50
    v_mov_b32 v128, s50
    s_getreg_b32 s70, hwreg(HW_REG_XCC_ID)
    v_mov_b32 v129, s70
    v_mov_b32 v130, s50
    v_mov_b32 v131, s50
    s_lshl_b32 s70, s92, 7
    s_add_u32 s70, s70, 16936960
    s_mov_b64 exec, 0xff
    buffer_store_dwordx4 v[128:131], v9, s[4:7], s70 offen sc1
    s_mov_b64 exec, -1
L_hwarm:
    s_cmp_lg_u32 s92, 255
    s_cbranch_scc1 L_exit
    v_lshlrev_b32 v5, 7, v1
    s_mov_b32 s100, 17039360
L_eploop:
    s_mov_b32 exec_lo, -1
    s_mov_b32 exec_hi, -1
    s_mov_b32 s71, 0
poll_63:
    buffer_load_dword v2, v5, s[4:7], s100 offen sc1
    s_add_u32 s71, s71, 1
    s_waitcnt vmcnt(0)
    v_cmp_ne_u32 vcc, s50, v2
    s_nop 3
    s_cbranch_vccz polld_64
    s_cmp_lt_u32 s71, 400000
    s_cbranch_scc1 poll_63
polld_64:
    s_mov_b64 exec, -1
    s_add_u32 s100, s100, 8192
    s_cmp_lt_u32 s100, 17154048
    s_cbranch_scc1 L_eploop
    s_mov_b32 s100, 16908288
L_eploop2:
    s_mov_b32 exec_lo, -1
    s_mov_b32 exec_hi, -1
    s_mov_b32 s71, 0
poll_66:
    buffer_load_dword v2, v5, s[4:7], s100 offen sc1
    s_add_u32 s71, s71, 1
    s_waitcnt vmcnt(0)
    v_cmp_ne_u32 vcc, s50, v2
    s_nop 3
    s_cbranch_vccz polld_67
    s_cmp_lt_u32 s71, 400000
    s_cbranch_scc1 poll_66
polld_67:
    s_mov_b64 exec, -1
    s_add_u32 s100, s100, 8192
    s_cmp_lt_u32 s100, 16965632
    s_cbranch_scc1 L_eploop2
    s_mov_b32 exec_lo, -1
    s_mov_b32 exec_hi, 0
    s_mov_b32 s71, 0
poll_69:
    buffer_load_dword v2, v5, s[4:7], s100 offen sc1
    s_add_u32 s71, s71, 1
    s_waitcnt vmcnt(0)
    v_cmp_ne_u32 vcc, s50, v2
    s_nop 3
    s_cbranch_vccz polld_70
    s_cmp_lt_u32 s71, 400000
    s_cbranch_scc1 poll_69
polld_70:
    s_mov_b64 exec, -1
    s_mov_b32 s70, 0
    s_mov_b64 exec, 0xff
    buffer_store_dwordx4 v[128:131], v9, s[4:7], s70 offen sc1
    s_mov_b64 exec, -1
L_exit:
    s_endpgm
    .p2align 4
    .type L_tbl,@object
L_tbl:
    .short 1536, 1280, 1280, 1280, 1280, 1278, 1278, 1278, 1278, 1278, 1278, 1278, 1270, 1270, 1270, 1270
    .short 1270, 1270, 1270, 1270, 1270, 1262, 1262, 1262, 1262, 1262, 1262, 1262, 1254, 1254, 1254, 1254
    .short 1254, 1254, 1254, 1254, 1254, 1246, 1246, 1246, 1246, 1246, 1246, 1246, 1238, 1238, 1238, 1238
    .short 1238, 1238, 1238, 1238, 1238, 1230, 1230, 1230, 1230, 1230, 1230, 1230, 1222, 1222, 1222, 1222
    .short 1222, 1222, 1222, 1222, 1222, 1214, 1214, 1214, 1214, 1214, 1214, 1214, 1206, 1206, 1206, 1206
    .short 1206, 1206, 1206, 1206, 1206, 1198, 1198, 1198, 1198, 1198, 1198, 1198, 1190, 1190, 1190, 1190
    .short 1190, 1190, 1190, 1190, 1190, 1182, 1182, 1182, 1182, 1182, 1182, 1182, 1174, 1174, 1174, 1174
    .short 1174, 1174, 1174, 1174, 1174, 1166, 1166, 1166, 1166, 1166, 1166, 1166, 1158, 1158, 1158, 1158
    .short 1158, 1158, 1158, 1158, 1158, 1276, 1276, 1276, 1276, 1276, 1276, 1276, 1268, 1268, 1268, 1268
    .short 1268, 1268, 1268, 1268, 1268, 1260, 1260, 1260, 1260, 1260, 1260, 1260, 1252, 1252, 1252, 1252
    .short 1252, 1252, 1252, 1252, 1252, 1244, 1244, 1244, 1244, 1244, 1244, 1244, 1236, 1236, 1236, 1236
    .short 1236, 1236, 1236, 1236, 1236, 1228, 1228, 1228, 1228, 1228, 1228, 1228, 1220, 1220, 1220, 1220
    .short 1220, 1220, 1220, 1220, 1220, 1212, 1212, 1212, 1212, 1212, 1212, 1212, 1204, 1204, 1204, 1204
    .short 1204, 1204, 1204, 1204, 1204, 1196, 1196, 1196, 1196, 1196, 1196, 1196, 1188, 1188, 1188, 1188
    .short 1188, 1188, 1188, 1188, 1188, 1180, 1180, 1180, 1180, 1180, 1180, 1180, 1172, 1172, 1172, 1172
    .short 1172, 1172, 1172, 1172, 1172, 1164, 1164, 1164, 1164, 1164, 1164, 1164, 1156, 1156, 1156, 1156
    .short 1156, 1156, 1156, 1156, 1156, 1274, 1274, 1274, 1274, 1274, 1274, 1274, 1266, 1266, 1266, 1266
    .short 1266, 1266, 1266, 1266, 1266, 1258, 1258, 1258, 1258, 1258, 1258, 1258, 1250, 1250, 1250, 1250
    .short 1250, 1250, 1250, 1250, 1250, 1242, 1242, 1242, 1242, 1242, 1242, 1242, 1234, 1234, 1234, 1234
    .short 1234, 1234, 1234, 1234, 1234, 1226, 1226, 1226, 1226, 1226, 1226, 1226, 1218, 1218, 1218, 1218
    .short 1218, 1218, 1218, 1218, 1218, 1210, 1210, 1210, 1210, 1210, 1210, 1210, 1202, 1202, 1202, 1202
    .short 1202, 1202, 1202, 1202, 1202, 1194, 1194, 1194, 1194, 1194, 1194, 1194, 1186, 1186, 1186, 1186
    .short 1186, 1186, 1186, 1186, 1186, 1178, 1178, 1178, 1178, 1178, 1178, 1178, 1170, 1170, 1170, 1170
    .short 1170, 1170, 1170, 1170, 1170, 1162, 1162, 1162, 1162, 1162, 1162, 1162, 1154, 1154, 1154, 1154
    .short 1154, 1154, 1154, 1154, 1154, 1272, 1272, 1272, 1272, 1272, 1272, 1272, 1264, 1264, 1264, 1264
    .short 1264, 1264, 1264, 1264, 1264, 1256, 1256, 1256, 1256, 1256, 1256, 1256, 1248, 1248, 1248, 1248
    .short 1248, 1248, 1248, 1248, 1248, 1240, 1240, 1240, 1240, 1240, 1240, 1240, 1232, 1232, 1232, 1232
    .short 1232, 1232, 1232, 1232, 1232, 1224, 1224, 1224, 1224, 1224, 1224, 1224, 1216, 1216, 1216, 1216
    .short 1216, 1216, 1216, 1216, 1216, 1208, 1208, 1208, 1208, 1208, 1208, 1208, 1200, 1200, 1200, 1200
    .short 1200, 1200, 1200, 1200, 1200, 1192, 1192, 1192, 1192, 1192, 1192, 1192, 1184, 1184, 1184, 1184
    .short 1184, 1184, 1184, 1184, 1184, 1176, 1176, 1176, 1176, 1176, 1176, 1176, 1168, 1168, 1168, 1168
    .short 1168, 1168, 1168, 1168, 1168, 1160, 1160, 1160, 1160, 1160, 1160, 1160, 1152, 1152, 1152, 1152
    .short 1152, 1152, 1152, 1152, 1152, 1150, 1150, 1150, 1150, 1150, 1150, 1150, 1142, 1142, 1142, 1142
    .short 1142, 1142, 1142, 1142, 1142, 1134, 1134, 1134, 1134, 1134, 1134, 1134, 1126, 1126, 1126, 1126
    .short 1126, 1126, 1126, 1126, 1126, 1118, 1118, 1118, 1118, 1118, 1118, 1118, 1110, 1110, 1110, 1110
    .short 1110, 1110, 1110, 1110, 1110, 1102, 1102, 1102, 1102, 1102, 1102, 1102, 1094, 1094, 1094, 1094
    .short 1094, 1094, 1094, 1094, 1094, 1086, 1086, 1086, 1086, 1086, 1086, 1086, 1078, 1078, 1078, 1078
    .short 1078, 1078, 1078, 1078, 1078, 1070, 1070, 1070, 1070, 1070, 1070, 1070, 1062, 1062, 1062, 1062
    .short 1062, 1062, 1062, 1062, 1062, 1054, 1054, 1054, 1054, 1054, 1054, 1054, 1046, 1046, 1046, 1046
    .short 1046, 1046, 1046, 1046, 1046, 1038, 1038, 1038, 1038, 1038, 1038, 1038, 1030, 1030, 1030, 1030
    .short 1030, 1030, 1030, 1030, 1030, 1148, 1148, 1148, 1148, 1148, 1148, 1148, 1140, 1140, 1140, 1140
    .short 1140, 1140, 1140, 1140, 1140, 1132, 1132, 1132, 1132, 1132, 1132, 1132, 1124, 1124, 1124, 1124
    .short 1124, 1124, 1124, 1124, 1124, 1116, 1116, 1116, 1116, 1116, 1116, 1116, 1108, 1108, 1108, 1108
    .short 1108, 1108, 1108, 1108, 1108, 1100, 1100, 1100, 1100, 1100, 1100, 1100, 1092, 1092, 1092, 1092
    .short 1092, 1092, 1092, 1092, 1092, 1084, 1084, 1084, 1084, 1084, 1084, 1084, 1076, 1076, 1076, 1076
    .short 1076, 1076, 1076, 1076, 1076, 1068, 1068, 1068, 1068, 1068, 1068, 1068, 1060, 1060, 1060, 1060
    .short 1060, 1060, 1060, 1060, 1060, 1052, 1052, 1052, 1052, 1052, 1052, 1052, 1044, 1044, 1044, 1044
    .short 1044, 1044, 1044, 1044, 1044, 1036, 1036, 1036, 1036, 1036, 1036, 1036, 1028, 1028, 1028, 1028
    .short 1028, 1028, 1028, 1028, 1028, 1146, 1146, 1146, 1146, 1146, 1146, 1146, 1138, 1138, 1138, 1138
    .short 1138, 1138, 1138, 1138, 1138, 1130, 1130, 1130, 1130, 1130, 1130, 1130, 1122, 1122, 1122, 1122
    .short 1122, 1122, 1122, 1122, 1122, 1114, 1114, 1114, 1114, 1114, 1114, 1114, 1106, 1106, 1106, 1106
    .short 1106, 1106, 1106, 1106, 1106, 1098, 1098, 1098, 1098, 1098, 1098, 1098, 1090, 1090, 1090, 1090
    .short 1090, 1090, 1090, 1090, 1090, 1082, 1082, 1082, 1082, 1082, 1082, 1082, 1074, 1074, 1074, 1074
    .short 1074, 1074, 1074, 1074, 1074, 1066, 1066, 1066, 1066, 1066, 1066, 1066, 1058, 1058, 1058, 1058
    .short 1058, 1058, 1058, 1058, 1058, 1050, 1050, 1050, 1050, 1050, 1050, 1050, 1042, 1042, 1042, 1042
    .short 1042, 1042, 1042, 1042, 1042, 1034, 1034, 1034, 1034, 1034, 1034, 1034, 1026, 1026, 1026, 1026
    .short 1026, 1026, 1026, 1026, 1026, 1144, 1144, 1144, 1144, 1144, 1144, 1144, 1136, 1136, 1136, 1136
    .short 1136, 1136, 1136, 1136, 1136, 1128, 1128, 1128, 1128, 1128, 1128, 1128, 1120, 1120, 1120, 1120
    .short 1120, 1120, 1120, 1120, 1120, 1112, 1112, 1112, 1112, 1112, 1112, 1112, 1104, 1104, 1104, 1104
    .short 1104, 1104, 1104, 1104, 1104, 1096, 1096, 1096, 1096, 1096, 1096, 1096, 1088, 1088, 1088, 1088
    .short 1088, 1088, 1088, 1088, 1088, 1080, 1080, 1080, 1080, 1080, 1080, 1080, 1072, 1072, 1072, 1072
    .short 1072, 1072, 1072, 1072, 1072, 1064, 1064, 1064, 1064, 1064, 1064, 1064, 1056, 1056, 1056, 1056
    .short 1056, 1056, 1056, 1056, 1056, 1048, 1048, 1048, 1048, 1048, 1048, 1048, 1040, 1040, 1040, 1040
    .short 1040, 1040, 1040, 1040, 1040, 1032, 1032, 1032, 1032, 1032, 1032, 1032, 1024, 1024, 1024, 1024
    .short 1024, 1024, 1024, 1022, 1022, 1022, 1020, 1020, 1020, 1020, 1020, 1014, 1014, 1014, 1012, 1012
    .short 1012, 1012, 1012, 1006, 1006, 1006, 1004, 1004, 1004, 1004, 1004, 998, 998, 998, 996, 996
    .short 996, 996, 996, 990, 990, 990, 988, 988, 988, 988, 988, 982, 982, 982, 980, 980
    .short 980, 980, 980, 974, 974, 974, 972, 972, 972, 972, 972, 966, 966, 966, 964, 964
    .short 964, 964, 964, 958, 958, 958, 956, 956, 956, 956, 956, 950, 950, 950, 948, 948
    .short 948, 948, 948, 942, 942, 942, 940, 940, 940, 940, 940, 934, 934, 934, 932, 932
    .short 932, 932, 932, 926, 926, 926, 924, 924, 924, 924, 924, 918, 918, 918, 916, 916
    .short 916, 916, 916, 910, 910, 910, 908, 908, 908, 908, 908, 902, 902, 902, 900, 900
    .short 900, 900, 900, 1018, 1018, 1018, 1016, 1016, 1016, 1016, 1016, 1010, 1010, 1010, 1008, 1008
    .short 1008, 1008, 1008, 1002, 1002, 1002, 1000, 1000, 1000, 1000, 1000, 994, 994, 994, 992, 992
    .short 992, 992, 992, 986, 986, 986, 984, 984, 984, 984, 984, 978, 978, 978, 976, 976
    .short 976, 976, 976, 970, 970, 970, 968, 968, 968, 968, 968, 962, 962, 962, 960, 960
    .short 960, 960, 960, 954, 954, 954, 952, 952, 952, 952, 952, 946, 946, 946, 944, 944
    .short 944, 944, 944, 938, 938, 938, 936, 936, 936, 936, 936, 930, 930, 930, 928, 928
    .short 928, 928, 928, 922, 922, 922, 920, 920, 920, 920, 920, 914, 914, 914, 912, 912
    .short 912, 912, 912, 906, 906, 906, 904, 904, 904, 904, 904, 898, 898, 898, 896, 896
    .short 896, 896, 896, 894, 894, 894, 892, 892, 892, 892, 892, 886, 886, 886, 884, 884
    .short 884, 884, 884, 878, 878, 878, 876, 876, 876, 876, 876, 870, 870, 870, 868, 868
    .short 868, 868, 868, 862, 862, 862, 860, 860, 860, 860, 860, 854, 854, 854, 852, 852
    .short 852, 852, 852, 846, 846, 846, 844, 844, 844, 844, 844, 838, 838, 838, 836, 836
    .short 836, 836, 836, 830, 830, 830, 828, 828, 828, 828, 828, 822, 822, 822, 820, 820
    .short 820, 820, 820, 814, 814, 814, 812, 812, 812, 812, 812, 806, 806, 806, 804, 804
    .short 804, 804, 804, 798, 798, 798, 796, 796, 796, 796, 796, 790, 790, 790, 788, 788
    .short 788, 788, 788, 782, 782, 782, 780, 780, 780, 780, 780, 774, 774, 774, 772, 772
    .short 772, 772, 772, 890, 890, 890, 888, 888, 888, 888, 888, 882, 882, 882, 880, 880
    .short 880, 880, 880, 874, 874, 874, 872, 872, 872, 872, 872, 866, 866, 866, 864, 864
    .short 864, 864, 864, 858, 858, 858, 856, 856, 856, 856, 856, 850, 850, 850, 848, 848
    .short 848, 848, 848, 842, 842, 842, 840, 840, 840, 840, 840, 834, 834, 834, 832, 832
    .short 832, 832, 832, 826, 826, 826, 824, 824, 824, 824, 824, 818, 818, 818, 816, 816
    .short 816, 816, 816, 810, 810, 810, 808, 808, 808, 808, 808, 802, 802, 802, 800, 800
    .short 800, 800, 800, 794, 794, 794, 792, 792, 792, 792, 792, 786, 786, 786, 784, 784
    .short 784, 784, 784, 778, 778, 778, 776, 776, 776, 776, 776, 770, 770, 770, 768, 768
    .short 768, 768, 766, 764, 764, 764, 762, 760, 760, 760, 758, 756, 756, 756, 754, 752
    .short 752, 752, 750, 748, 748, 748, 746, 744, 744, 744, 742, 740, 740, 740, 738, 736
    .short 736, 736, 734, 732, 732, 732, 730, 728, 728, 728, 726, 724, 724, 724, 722, 720
    .short 720, 720, 718, 716, 716, 716, 714, 712, 712, 712, 710, 708, 708, 708, 706, 704
    .short 704, 704, 702, 700, 700, 700, 698, 696, 696, 696, 694, 692, 692, 692, 690, 688
    .short 688, 688, 686, 684, 684, 684, 682, 680, 680, 680, 678, 676, 676, 676, 674, 672
    .short 672, 672, 670, 668, 668, 668, 666, 664, 664, 664, 662, 660, 660, 660, 658, 656
    .short 656, 656, 654, 652, 652, 652, 650, 648, 648, 648, 646, 644, 644, 644, 642, 640
    .short 640, 640, 638, 636, 636, 636, 634, 632, 632, 632, 630, 628, 628, 628, 626, 624
    .short 624, 624, 622, 620, 620, 620, 618, 616, 616, 616, 614, 612, 612, 612, 610, 608
    .short 608, 608, 606, 604, 604, 604, 602, 600, 600, 600, 598, 596, 596, 596, 594, 592
    .short 592, 592, 590, 588, 588, 588, 586, 584, 584, 584, 582, 580, 580, 580, 578, 576
    .short 576, 576, 574, 572, 572, 572, 570, 568, 568, 568, 566, 564, 564, 564, 562, 560
    .short 560, 560, 558, 556, 556, 556, 554, 552, 552, 552, 550, 548, 548, 548, 546, 544
    .short 544, 544, 542, 540, 540, 540, 538, 536, 536, 536, 534, 532, 532, 532, 530, 528
    .short 528, 528, 526, 524, 524, 524, 522, 520, 520, 520, 518, 516, 516, 516, 514, 512
    .short 512, 510, 508, 506, 504, 382, 380, 378, 376, 502, 500, 498, 496, 374, 372, 370
    .short 368, 494, 492, 490, 488, 366, 364, 362, 360, 486, 484, 482, 480, 358, 356, 354
    .short 352, 478, 476, 474, 472, 350, 348, 346, 344, 470, 468, 466, 464, 342, 340, 338
    .short 336, 462, 460, 458, 456, 334, 332, 330, 328, 454, 452, 450, 448, 326, 324, 322
    .short 320, 446, 444, 442, 440, 318, 316, 314, 312, 438, 436, 434, 432, 310, 308, 306
    .short 304, 430, 428, 426, 424, 302, 300, 298, 296, 422, 420, 418, 416, 294, 292, 290
    .short 288, 414, 412, 410, 408, 286, 284, 282, 280, 406, 404, 402, 400, 278, 276, 274
    .short 272, 398, 396, 394, 392, 270, 268, 266, 264, 390, 388, 386, 384, 262, 260, 258
    .short 256, 254, 252, 250, 248, 126, 124, 122, 120, 246, 244, 242, 240, 118, 116, 114
    .short 112, 238, 236, 234, 232, 110, 108, 106, 104, 230, 228, 226, 224, 102, 100, 98
    .short 96, 222, 220, 218, 216, 94, 92, 90, 88, 214, 212, 210, 208, 86, 84, 82
    .short 80, 206, 204, 202, 200, 78, 76, 74, 72, 198, 196, 194, 192, 70, 68, 66
    .short 64, 190, 188, 186, 184, 62, 60, 58, 56, 182, 180, 178, 176, 54, 52, 50
    .short 48, 174, 172, 170, 168, 46, 44, 42, 40, 166, 164, 162, 160, 38, 36, 34
    .short 32, 158, 156, 154, 152, 30, 28, 26, 24, 150, 148, 146, 144, 22, 20, 18
    .short 16, 142, 140, 138, 136, 14, 12, 10, 8, 134, 132, 130, 128, 6, 4, 2
    .short 0, 1536, 1536, 1536, 1536, 1536, 1536, 1536, 1536, 1536, 1536, 1536, 1536, 1536, 1536, 1536
L_code_end:
.section .rodata,"a"
.p2align 6
.amdhsa_kernel recurrent_scan__ssm_conv_s4__mixer_s_mlp__prompt_kernel
  .amdhsa_next_free_vgpr 256
  .amdhsa_next_free_sgpr 102
  .amdhsa_accum_offset 256
  .amdhsa_group_segment_fixed_size 0
  .amdhsa_kernarg_size 136
  .amdhsa_user_sgpr_count 2
  .amdhsa_user_sgpr_kernarg_segment_ptr 1
  .amdhsa_system_sgpr_workgroup_id_x 1
.end_amdhsa_kernel
```
